```python
import torch

def _softmax(x, axis=-1):
    return torch.softmax(x, dim=axis)
def _gelu(x):
    return torch.nn.functional.gelu(x, approximate="tanh")
def _silu(x):
    return torch.nn.functional.silu(x)
def _sigmoid(x):
    return torch.sigmoid(x)
def _layernorm(x, axis=-1, eps=1e-5):
    m = x.mean(dim=axis, keepdim=True)
    v = x.var(dim=axis, keepdim=True, unbiased=False)
    return (x - m) / torch.sqrt(v + eps)
def _scatter_add(tgt, idx, src, axis=0):
    return tgt.clone().index_add_(axis, idx, src)
def _segment_sum(src, seg, n):
    out = torch.zeros((n,) + src.shape[1:], dtype=src.dtype)
    return out.index_add_(0, seg, src)
def _pad(x, pw):
    flat = tuple(v for pair in reversed(pw) for v in pair)
    return torch.nn.functional.pad(x, flat)

kernel_name = 'concat_heads__ssm_conv_s4d__softmax_full_mha__prompt'

def setup_inputs():

    _w = (lambda a: (lambda t: t.to(torch.bfloat16) if t.is_floating_point() else t)(torch.as_tensor(a)))
    def _A_setup():
        Bsz, L, D, N = 1, 2048, 512, 128
        return {
            "u": _w((lambda *s: torch.randn(*s, dtype=torch.bfloat16) * 0.05)(Bsz, L, D)),
            "log_A_real": _w((lambda *s: torch.randn(*s, dtype=torch.bfloat16) * 6.4)(D, N) * 0.5),
            "A_imag": _w((lambda *s: torch.randn(*s, dtype=torch.bfloat16) * 0.1)(D, N) * 3.14),
            "C_real": _w((lambda *s: torch.randn(*s, dtype=torch.bfloat16) * 0.4)(D, N) / N ** 0.5),
            "C_imag": _w((lambda *s: torch.randn(*s, dtype=torch.bfloat16) * 0.4)(D, N) / N ** 0.5),
            "log_dt": _w((lambda *s: torch.randn(*s, dtype=torch.bfloat16) * 0.1)(D) * 0.5 - 4.0),
            "D_skip": _w((lambda *s: torch.randn(*s, dtype=torch.bfloat16) * 0.1)(D)),
        }
    _A_in = _A_setup()

    def _B_setup():
        B, S, D = 1, 2048, 512
        return {
            "x": _w((lambda *s: torch.randn(*s, dtype=torch.bfloat16) * 0.2)(B, S, D)),
            "wqkv": _w((lambda *s: torch.randn(*s, dtype=torch.bfloat16) * 0.2)(D, 3 * D)),
            "wo": _w((lambda *s: torch.randn(*s, dtype=torch.bfloat16) * 0.05)(D, D)),
        }
    _B_in = _B_setup()

    return {
        "A_u": _A_in["u"],
        "A_log_A_real": _A_in["log_A_real"],
        "A_A_imag": _A_in["A_imag"],
        "A_C_real": _A_in["C_real"],
        "A_C_imag": _A_in["C_imag"],
        "A_log_dt": _A_in["log_dt"],
        "A_D_skip": _A_in["D_skip"],
        "B_x": _B_in["x"],
        "B_wqkv": _B_in["wqkv"],
        "B_wo": _B_in["wo"],
    }

def reference(A_u, A_log_A_real, A_A_imag, A_C_real, A_C_imag, A_log_dt, A_D_skip, B_x, B_wqkv, B_wo):
    def _A_ref(u, log_A_real, A_imag, C_real, C_imag, log_dt, D_skip):
        L = u.shape[1]
        dt = torch.exp(log_dt)
        A = -torch.exp(log_A_real) + 1j * A_imag
        C = (C_real + 1j * C_imag) * dt[:, None]
        pos = (lambda x, dt: x.to(dt))(torch.arange(L), log_dt.dtype)
        P = torch.exp((A * dt[:, None])[:, :, None] * pos[None, None, :])
        K = 2.0 * torch.einsum("dn,dnl->dl", C, P).real
        L2 = 2 * L
        u_t = (lambda x, *d: x.permute(*d))(u, 0, 2, 1)
        Kf = (lambda x, *a, **k: torch.fft.rfft(x.float(), *a, **k))(K, L2)
        Uf = (lambda x, *a, **k: torch.fft.rfft(x.float(), *a, **k))(u_t, L2)
        y = (lambda x, *a, **k: torch.fft.irfft(x, *a, **k).to(torch.bfloat16))(Uf * Kf[None, :, :], L2)[:, :, :L]
        y = (lambda x, *d: x.permute(*d))(y, 0, 2, 1)
        return y + u * D_skip[None, None, :]

    def _B_ref(x, wqkv, wo):
        B, S, D = x.shape
        H = 32; Dh = D // H
        qkv = (lambda x, *d: x.permute(*d))((x @ wqkv).reshape(B, S, 3, H, Dh), 2, 0, 3, 1, 4)
        q, k, v = qkv[0], qkv[1], qkv[2]
        scale = Dh ** -0.5
        scores = torch.einsum("bhqd,bhkd->bhqk", q, k) * scale
        p = _softmax(scores, axis=-1)
        o = torch.einsum("bhqk,bhkd->bhqd", p, v)
        return (lambda x, *d: x.permute(*d))(o, 0, 2, 1, 3).reshape(B, S, D) @ wo

    a = _A_ref(A_u, A_log_A_real, A_A_imag, A_C_real, A_C_imag, A_log_dt, A_D_skip)
    b = _B_ref(B_x, B_wqkv, B_wo)
    return torch.concatenate([a, b], axis=-1)
```

```asm
; @launch kernel=l1_kernel grid=(512,1,1) block=(256,1,1) lds=57344
; @launch kernel=l2_kernel grid=(512,1,1) block=(512,1,1) lds=78912
; @launch kernel=gemm2_kernel grid=(256,1,1) block=(256,1,1) lds=65536
.amdgcn_target "amdgcn-amd-amdhsa--gfx950"
.text
.globl l1_kernel
.p2align 8
.type l1_kernel,@function
l1_kernel:
    s_cmp_ge_u32 s2, 512
    s_cbranch_scc1 l1_kernel_end
    s_cmp_lt_u32 s2, 256
    s_cbranch_scc1 SECOND_l1_kernel_1
    s_sub_u32 s2, s2, 256
    s_setprio 3
    s_load_dwordx2 s[4:5], s[0:1], 56
    s_load_dwordx2 s[6:7], s[0:1], 64
    s_load_dwordx2 s[8:9], s[0:1], 96
    v_lshrrev_b32 v1, 6, v0
    v_and_b32 v0, 63, v0
    s_nop 0
    v_readfirstlane_b32 s3, v1
    s_and_b32 s26, s2, 7
    s_lshr_b32 s27, s2, 3
    s_lshr_b32 s24, s26, 1
    s_lshl_b32 s24, s24, 2
    s_and_b32 s28, s27, 3
    s_add_u32 s24, s24, s28
    s_and_b32 s25, s26, 1
    s_lshl_b32 s25, s25, 3
    s_lshr_b32 s28, s27, 2
    s_add_u32 s25, s25, s28
    s_waitcnt lgkmcnt(0)
    s_mov_b32 s12, s4
    s_and_b32 s13, s5, 0xffff
    s_mov_b32 s14, 2097152
    s_mov_b32 s15, 0x00020000
    s_mov_b32 s16, s6
    s_and_b32 s17, s7, 0xffff
    s_mov_b32 s18, 1572864
    s_mov_b32 s19, 0x00020000
    s_mov_b32 s20, s8
    s_and_b32 s21, s9, 0xffff
    s_mov_b32 s22, 13631488
    s_mov_b32 s23, 0x00020000
    s_lshl_b32 s26, s24, 7
    s_lshl_b32 s27, s3, 5
    s_add_u32 s26, s26, s27
    v_and_b32 v2, 31, v0
    v_add_u32 v2, s26, v2
    v_lshlrev_b32 v2, 10, v2
    v_lshrrev_b32 v3, 5, v0
    v_lshlrev_b32 v3, 4, v3
    v_add_u32 v2, v2, v3
    s_movk_i32 s28, 171
    s_movk_i32 s29, 3072
    v_add_u32 v3, 0, v0
    v_mul_lo_u32 v7, v3, s28
    v_lshrrev_b32 v7, 11, v7
    v_mul_u32_u24 v8, 12, v7
    v_sub_u32 v8, v3, v8
    v_mul_lo_u32 v7, v7, s29
    v_lshlrev_b32 v8, 4, v8
    v_add_u32 v4, v7, v8
    v_add_u32 v3, 64, v0
    v_mul_lo_u32 v7, v3, s28
    v_lshrrev_b32 v7, 11, v7
    v_mul_u32_u24 v8, 12, v7
    v_sub_u32 v8, v3, v8
    v_mul_lo_u32 v7, v7, s29
    v_lshlrev_b32 v8, 4, v8
    v_add_u32 v5, v7, v8
    v_add_u32 v3, 128, v0
    v_mul_lo_u32 v7, v3, s28
    v_lshrrev_b32 v7, 11, v7
    v_mul_u32_u24 v8, 12, v7
    v_sub_u32 v8, v3, v8
    v_mul_lo_u32 v7, v7, s29
    v_lshlrev_b32 v8, 4, v8
    v_add_u32 v6, v7, v8
    v_lshrrev_b32 v7, 5, v0
    v_lshlrev_b32 v7, 3, v7
    v_and_b32 v8, 15, v0
    v_lshrrev_b32 v8, 2, v8
    v_add_u32 v7, v7, v8
    v_mul_u32_u24 v7, 192, v7
    v_lshrrev_b32 v8, 4, v0
    v_and_b32 v8, 1, v8
    v_lshlrev_b32 v8, 5, v8
    v_add_u32 v7, v7, v8
    v_and_b32 v8, 3, v0
    v_lshlrev_b32 v8, 3, v8
    v_add_u32 v7, v7, v8
    v_mov_b32 v16, 0
    v_mov_b32 v17, 0
    v_mov_b32 v18, 0
    v_mov_b32 v19, 0
    v_mov_b32 v20, 0
    v_mov_b32 v21, 0
    v_mov_b32 v22, 0
    v_mov_b32 v23, 0
    v_mov_b32 v24, 0
    v_mov_b32 v25, 0
    v_mov_b32 v26, 0
    v_mov_b32 v27, 0
    v_mov_b32 v28, 0
    v_mov_b32 v29, 0
    v_mov_b32 v30, 0
    v_mov_b32 v31, 0
    v_mov_b32 v32, 0
    v_mov_b32 v33, 0
    v_mov_b32 v34, 0
    v_mov_b32 v35, 0
    v_mov_b32 v36, 0
    v_mov_b32 v37, 0
    v_mov_b32 v38, 0
    v_mov_b32 v39, 0
    v_mov_b32 v40, 0
    v_mov_b32 v41, 0
    v_mov_b32 v42, 0
    v_mov_b32 v43, 0
    v_mov_b32 v44, 0
    v_mov_b32 v45, 0
    v_mov_b32 v46, 0
    v_mov_b32 v47, 0
    v_mov_b32 v48, 0
    v_mov_b32 v49, 0
    v_mov_b32 v50, 0
    v_mov_b32 v51, 0
    v_mov_b32 v52, 0
    v_mov_b32 v53, 0
    v_mov_b32 v54, 0
    v_mov_b32 v55, 0
    v_mov_b32 v56, 0
    v_mov_b32 v57, 0
    v_mov_b32 v58, 0
    v_mov_b32 v59, 0
    v_mov_b32 v60, 0
    v_mov_b32 v61, 0
    v_mov_b32 v62, 0
    v_mov_b32 v63, 0
    s_mul_i32 s30, s25, 192
    s_lshl_b32 s42, s3, 4
    s_mul_i32 s43, s42, 3072
    s_add_u32 s43, s43, s30
    s_mul_i32 s44, s42, 192
    v_lshrrev_b32 v10, 3, v0
    v_lshrrev_b32 v11, 1, v10
    v_and_b32 v12, 7, v0
    v_xor_b32 v12, v12, v11
    v_lshlrev_b32 v10, 10, v10
    v_lshlrev_b32 v13, 4, v12
    v_add_u32 v8, v10, v13
    v_xor_b32 v12, 4, v12
    v_lshlrev_b32 v13, 4, v12
    v_add_u32 v9, v10, v13
    s_lshl_b32 s47, s26, 10
    s_lshl_b32 s48, s3, 12
    v_and_b32 v10, 31, v0
    v_lshrrev_b32 v11, 1, v10
    v_and_b32 v11, 7, v11
    v_lshrrev_b32 v12, 5, v0
    v_lshlrev_b32 v10, 7, v10
    v_add_u32 v10, s48, v10
    v_add_u32 v10, 24576, v10
    v_add_u32 v13, 0, v12
    v_xor_b32 v13, v13, v11
    v_lshlrev_b32 v13, 4, v13
    v_add_u32 v88, v10, v13
    v_add_u32 v13, 2, v12
    v_xor_b32 v13, v13, v11
    v_lshlrev_b32 v13, 4, v13
    v_add_u32 v89, v10, v13
    v_add_u32 v13, 4, v12
    v_xor_b32 v13, v13, v11
    v_lshlrev_b32 v13, 4, v13
    v_add_u32 v90, v10, v13
    v_add_u32 v13, 6, v12
    v_xor_b32 v13, v13, v11
    v_lshlrev_b32 v13, 4, v13
    v_add_u32 v91, v10, v13
    s_add_u32 s34, s44, 0
    s_mov_b32 m0, s34
    s_nop 0
    buffer_load_dwordx4 v4, s[16:19], s43 offen lds
    s_add_u32 s34, s44, 1024
    s_mov_b32 m0, s34
    s_nop 0
    buffer_load_dwordx4 v5, s[16:19], s43 offen lds
    s_add_u32 s34, s44, 2048
    s_mov_b32 m0, s34
    s_nop 0
    buffer_load_dwordx4 v6, s[16:19], s43 offen lds
    s_add_u32 s34, s48, 24576
    s_mov_b32 m0, s34
    s_add_u32 s49, s47, 0
    buffer_load_dwordx4 v8, s[12:15], s49 offen lds
    s_add_u32 s34, s48, 25600
    s_mov_b32 m0, s34
    s_add_u32 s49, s47, 8192
    buffer_load_dwordx4 v9, s[12:15], s49 offen lds
    s_add_u32 s34, s48, 26624
    s_mov_b32 m0, s34
    s_add_u32 s49, s47, 16384
    buffer_load_dwordx4 v8, s[12:15], s49 offen lds
    s_add_u32 s34, s48, 27648
    s_mov_b32 m0, s34
    s_add_u32 s49, s47, 24576
    buffer_load_dwordx4 v9, s[12:15], s49 offen lds
    s_add_u32 s43, s43, 196608
    s_add_u32 s47, s47, 128
    s_mov_b32 s46, 0
LP_l1_kernel_3:
    s_waitcnt vmcnt(0)
    s_barrier
    ds_read_b128 v[128:131], v88 offset:0
    ds_read_b64_tr_b16 v[64:65], v7 offset:0
    ds_read_b64_tr_b16 v[66:67], v7 offset:768
    ds_read_b64_tr_b16 v[68:69], v7 offset:64
    ds_read_b64_tr_b16 v[70:71], v7 offset:832
    ds_read_b64_tr_b16 v[72:73], v7 offset:128
    ds_read_b64_tr_b16 v[74:75], v7 offset:896
    s_add_u32 s34, s44, 12288
    s_mov_b32 m0, s34
    s_nop 0
    buffer_load_dwordx4 v4, s[16:19], s43 offen lds
    s_add_u32 s34, s44, 13312
    s_mov_b32 m0, s34
    s_nop 0
    buffer_load_dwordx4 v5, s[16:19], s43 offen lds
    s_add_u32 s34, s44, 14336
    s_mov_b32 m0, s34
    s_nop 0
    buffer_load_dwordx4 v6, s[16:19], s43 offen lds
    s_add_u32 s34, s48, 40960
    s_mov_b32 m0, s34
    s_add_u32 s49, s47, 0
    buffer_load_dwordx4 v8, s[12:15], s49 offen lds
    s_add_u32 s34, s48, 41984
    s_mov_b32 m0, s34
    s_add_u32 s49, s47, 8192
    buffer_load_dwordx4 v9, s[12:15], s49 offen lds
    s_add_u32 s34, s48, 43008
    s_mov_b32 m0, s34
    s_add_u32 s49, s47, 16384
    buffer_load_dwordx4 v8, s[12:15], s49 offen lds
    s_add_u32 s34, s48, 44032
    s_mov_b32 m0, s34
    s_add_u32 s49, s47, 24576
    buffer_load_dwordx4 v9, s[12:15], s49 offen lds
    s_add_u32 s43, s43, 196608
    s_add_u32 s47, s47, 128
    ds_read_b128 v[132:135], v89 offset:0
    ds_read_b64_tr_b16 v[76:77], v7 offset:3072
    ds_read_b64_tr_b16 v[78:79], v7 offset:3840
    ds_read_b64_tr_b16 v[80:81], v7 offset:3136
    ds_read_b64_tr_b16 v[82:83], v7 offset:3904
    ds_read_b64_tr_b16 v[84:85], v7 offset:3200
    ds_read_b64_tr_b16 v[86:87], v7 offset:3968
    s_waitcnt lgkmcnt(7)
    s_cmp_gt_u32 s25, 10
    s_cbranch_scc1 A_l1_kernel_4
    v_mfma_f32_32x32x16_bf16 v[16:31], v[64:67], v[128:131], v[16:31]
    v_mfma_f32_32x32x16_bf16 v[32:47], v[68:71], v[128:131], v[32:47]
    s_cmp_eq_u32 s25, 10
    s_cbranch_scc1 C_l1_kernel_6
    v_mfma_f32_32x32x16_bf16 v[48:63], v[72:75], v[128:131], v[48:63]
    s_branch D_l1_kernel_7
A_l1_kernel_4:
    v_mfma_f32_32x32x16_bf16 v[16:31], v[128:131], v[64:67], v[16:31]
    v_mfma_f32_32x32x16_bf16 v[32:47], v[128:131], v[68:71], v[32:47]
C_l1_kernel_6:
    v_mfma_f32_32x32x16_bf16 v[48:63], v[128:131], v[72:75], v[48:63]
D_l1_kernel_7:
    ds_read_b128 v[128:131], v90 offset:0
    ds_read_b64_tr_b16 v[64:65], v7 offset:6144
    ds_read_b64_tr_b16 v[66:67], v7 offset:6912
    ds_read_b64_tr_b16 v[68:69], v7 offset:6208
    ds_read_b64_tr_b16 v[70:71], v7 offset:6976
    ds_read_b64_tr_b16 v[72:73], v7 offset:6272
    ds_read_b64_tr_b16 v[74:75], v7 offset:7040
    s_waitcnt lgkmcnt(7)
    s_cmp_gt_u32 s25, 10
    s_cbranch_scc1 A_l1_kernel_8
    v_mfma_f32_32x32x16_bf16 v[16:31], v[76:79], v[132:135], v[16:31]
    v_mfma_f32_32x32x16_bf16 v[32:47], v[80:83], v[132:135], v[32:47]
    s_cmp_eq_u32 s25, 10
    s_cbranch_scc1 C_l1_kernel_10
    v_mfma_f32_32x32x16_bf16 v[48:63], v[84:87], v[132:135], v[48:63]
    s_branch D_l1_kernel_11
A_l1_kernel_8:
    v_mfma_f32_32x32x16_bf16 v[16:31], v[132:135], v[76:79], v[16:31]
    v_mfma_f32_32x32x16_bf16 v[32:47], v[132:135], v[80:83], v[32:47]
C_l1_kernel_10:
    v_mfma_f32_32x32x16_bf16 v[48:63], v[132:135], v[84:87], v[48:63]
D_l1_kernel_11:
    ds_read_b128 v[132:135], v91 offset:0
    ds_read_b64_tr_b16 v[76:77], v7 offset:9216
    ds_read_b64_tr_b16 v[78:79], v7 offset:9984
    ds_read_b64_tr_b16 v[80:81], v7 offset:9280
    ds_read_b64_tr_b16 v[82:83], v7 offset:10048
    ds_read_b64_tr_b16 v[84:85], v7 offset:9344
    ds_read_b64_tr_b16 v[86:87], v7 offset:10112
    s_waitcnt lgkmcnt(7)
    s_cmp_gt_u32 s25, 10
    s_cbranch_scc1 A_l1_kernel_12
    v_mfma_f32_32x32x16_bf16 v[16:31], v[64:67], v[128:131], v[16:31]
    v_mfma_f32_32x32x16_bf16 v[32:47], v[68:71], v[128:131], v[32:47]
    s_cmp_eq_u32 s25, 10
    s_cbranch_scc1 C_l1_kernel_14
    v_mfma_f32_32x32x16_bf16 v[48:63], v[72:75], v[128:131], v[48:63]
    s_branch D_l1_kernel_15
A_l1_kernel_12:
    v_mfma_f32_32x32x16_bf16 v[16:31], v[128:131], v[64:67], v[16:31]
    v_mfma_f32_32x32x16_bf16 v[32:47], v[128:131], v[68:71], v[32:47]
C_l1_kernel_14:
    v_mfma_f32_32x32x16_bf16 v[48:63], v[128:131], v[72:75], v[48:63]
D_l1_kernel_15:
    s_waitcnt lgkmcnt(0)
    s_cmp_gt_u32 s25, 10
    s_cbranch_scc1 A_l1_kernel_16
    v_mfma_f32_32x32x16_bf16 v[16:31], v[76:79], v[132:135], v[16:31]
    v_mfma_f32_32x32x16_bf16 v[32:47], v[80:83], v[132:135], v[32:47]
    s_cmp_eq_u32 s25, 10
    s_cbranch_scc1 C_l1_kernel_18
    v_mfma_f32_32x32x16_bf16 v[48:63], v[84:87], v[132:135], v[48:63]
    s_branch D_l1_kernel_19
A_l1_kernel_16:
    v_mfma_f32_32x32x16_bf16 v[16:31], v[132:135], v[76:79], v[16:31]
    v_mfma_f32_32x32x16_bf16 v[32:47], v[132:135], v[80:83], v[32:47]
C_l1_kernel_18:
    v_mfma_f32_32x32x16_bf16 v[48:63], v[132:135], v[84:87], v[48:63]
D_l1_kernel_19:
    s_waitcnt vmcnt(0)
    s_barrier
    ds_read_b128 v[128:131], v88 offset:16384
    ds_read_b64_tr_b16 v[64:65], v7 offset:12288
    ds_read_b64_tr_b16 v[66:67], v7 offset:13056
    ds_read_b64_tr_b16 v[68:69], v7 offset:12352
    ds_read_b64_tr_b16 v[70:71], v7 offset:13120
    ds_read_b64_tr_b16 v[72:73], v7 offset:12416
    ds_read_b64_tr_b16 v[74:75], v7 offset:13184
    s_cmp_eq_u32 s46, 3
    s_cbranch_scc1 SK_l1_kernel_20
    s_add_u32 s34, s44, 0
    s_mov_b32 m0, s34
    s_nop 0
    buffer_load_dwordx4 v4, s[16:19], s43 offen lds
    s_add_u32 s34, s44, 1024
    s_mov_b32 m0, s34
    s_nop 0
    buffer_load_dwordx4 v5, s[16:19], s43 offen lds
    s_add_u32 s34, s44, 2048
    s_mov_b32 m0, s34
    s_nop 0
    buffer_load_dwordx4 v6, s[16:19], s43 offen lds
    s_add_u32 s34, s48, 24576
    s_mov_b32 m0, s34
    s_add_u32 s49, s47, 0
    buffer_load_dwordx4 v8, s[12:15], s49 offen lds
    s_add_u32 s34, s48, 25600
    s_mov_b32 m0, s34
    s_add_u32 s49, s47, 8192
    buffer_load_dwordx4 v9, s[12:15], s49 offen lds
    s_add_u32 s34, s48, 26624
    s_mov_b32 m0, s34
    s_add_u32 s49, s47, 16384
    buffer_load_dwordx4 v8, s[12:15], s49 offen lds
    s_add_u32 s34, s48, 27648
    s_mov_b32 m0, s34
    s_add_u32 s49, s47, 24576
    buffer_load_dwordx4 v9, s[12:15], s49 offen lds
    s_add_u32 s43, s43, 196608
    s_add_u32 s47, s47, 128
SK_l1_kernel_20:
    ds_read_b128 v[132:135], v89 offset:16384
    ds_read_b64_tr_b16 v[76:77], v7 offset:15360
    ds_read_b64_tr_b16 v[78:79], v7 offset:16128
    ds_read_b64_tr_b16 v[80:81], v7 offset:15424
    ds_read_b64_tr_b16 v[82:83], v7 offset:16192
    ds_read_b64_tr_b16 v[84:85], v7 offset:15488
    ds_read_b64_tr_b16 v[86:87], v7 offset:16256
    s_waitcnt lgkmcnt(7)
    s_cmp_gt_u32 s25, 10
    s_cbranch_scc1 A_l1_kernel_21
    v_mfma_f32_32x32x16_bf16 v[16:31], v[64:67], v[128:131], v[16:31]
    v_mfma_f32_32x32x16_bf16 v[32:47], v[68:71], v[128:131], v[32:47]
    s_cmp_eq_u32 s25, 10
    s_cbranch_scc1 C_l1_kernel_23
    v_mfma_f32_32x32x16_bf16 v[48:63], v[72:75], v[128:131], v[48:63]
    s_branch D_l1_kernel_24
A_l1_kernel_21:
    v_mfma_f32_32x32x16_bf16 v[16:31], v[128:131], v[64:67], v[16:31]
    v_mfma_f32_32x32x16_bf16 v[32:47], v[128:131], v[68:71], v[32:47]
C_l1_kernel_23:
    v_mfma_f32_32x32x16_bf16 v[48:63], v[128:131], v[72:75], v[48:63]
D_l1_kernel_24:
    ds_read_b128 v[128:131], v90 offset:16384
    ds_read_b64_tr_b16 v[64:65], v7 offset:18432
    ds_read_b64_tr_b16 v[66:67], v7 offset:19200
    ds_read_b64_tr_b16 v[68:69], v7 offset:18496
    ds_read_b64_tr_b16 v[70:71], v7 offset:19264
    ds_read_b64_tr_b16 v[72:73], v7 offset:18560
    ds_read_b64_tr_b16 v[74:75], v7 offset:19328
    s_waitcnt lgkmcnt(7)
    s_cmp_gt_u32 s25, 10
    s_cbranch_scc1 A_l1_kernel_25
    v_mfma_f32_32x32x16_bf16 v[16:31], v[76:79], v[132:135], v[16:31]
    v_mfma_f32_32x32x16_bf16 v[32:47], v[80:83], v[132:135], v[32:47]
    s_cmp_eq_u32 s25, 10
    s_cbranch_scc1 C_l1_kernel_27
    v_mfma_f32_32x32x16_bf16 v[48:63], v[84:87], v[132:135], v[48:63]
    s_branch D_l1_kernel_28
A_l1_kernel_25:
    v_mfma_f32_32x32x16_bf16 v[16:31], v[132:135], v[76:79], v[16:31]
    v_mfma_f32_32x32x16_bf16 v[32:47], v[132:135], v[80:83], v[32:47]
C_l1_kernel_27:
    v_mfma_f32_32x32x16_bf16 v[48:63], v[132:135], v[84:87], v[48:63]
D_l1_kernel_28:
    ds_read_b128 v[132:135], v91 offset:16384
    ds_read_b64_tr_b16 v[76:77], v7 offset:21504
    ds_read_b64_tr_b16 v[78:79], v7 offset:22272
    ds_read_b64_tr_b16 v[80:81], v7 offset:21568
    ds_read_b64_tr_b16 v[82:83], v7 offset:22336
    ds_read_b64_tr_b16 v[84:85], v7 offset:21632
    ds_read_b64_tr_b16 v[86:87], v7 offset:22400
    s_waitcnt lgkmcnt(7)
    s_cmp_gt_u32 s25, 10
    s_cbranch_scc1 A_l1_kernel_29
    v_mfma_f32_32x32x16_bf16 v[16:31], v[64:67], v[128:131], v[16:31]
    v_mfma_f32_32x32x16_bf16 v[32:47], v[68:71], v[128:131], v[32:47]
    s_cmp_eq_u32 s25, 10
    s_cbranch_scc1 C_l1_kernel_31
    v_mfma_f32_32x32x16_bf16 v[48:63], v[72:75], v[128:131], v[48:63]
    s_branch D_l1_kernel_32
A_l1_kernel_29:
    v_mfma_f32_32x32x16_bf16 v[16:31], v[128:131], v[64:67], v[16:31]
    v_mfma_f32_32x32x16_bf16 v[32:47], v[128:131], v[68:71], v[32:47]
C_l1_kernel_31:
    v_mfma_f32_32x32x16_bf16 v[48:63], v[128:131], v[72:75], v[48:63]
D_l1_kernel_32:
    s_waitcnt lgkmcnt(0)
    s_cmp_gt_u32 s25, 10
    s_cbranch_scc1 A_l1_kernel_33
    v_mfma_f32_32x32x16_bf16 v[16:31], v[76:79], v[132:135], v[16:31]
    v_mfma_f32_32x32x16_bf16 v[32:47], v[80:83], v[132:135], v[32:47]
    s_cmp_eq_u32 s25, 10
    s_cbranch_scc1 C_l1_kernel_35
    v_mfma_f32_32x32x16_bf16 v[48:63], v[84:87], v[132:135], v[48:63]
    s_branch D_l1_kernel_36
A_l1_kernel_33:
    v_mfma_f32_32x32x16_bf16 v[16:31], v[132:135], v[76:79], v[16:31]
    v_mfma_f32_32x32x16_bf16 v[32:47], v[132:135], v[80:83], v[32:47]
C_l1_kernel_35:
    v_mfma_f32_32x32x16_bf16 v[48:63], v[132:135], v[84:87], v[48:63]
D_l1_kernel_36:
    s_add_u32 s46, s46, 1
    s_cmp_lt_u32 s46, 4
    s_cbranch_scc1 LP_l1_kernel_3
EPI_l1_kernel_2:
    s_nop 15
    v_lshlrev_b32 v2, 4, v0
    v_and_b32 v3, 15, v0
    v_lshlrev_b32 v3, 4, v3
    v_lshrrev_b32 v4, 5, v0
    v_lshlrev_b32 v4, 8, v4
    v_add_u32 v3, v3, v4
    v_lshrrev_b32 v4, 4, v0
    v_and_b32 v4, 1, v4
    v_lshlrev_b32 v4, 16, v4
    v_add_u32 v3, v3, v4
    s_lshl_b32 s35, s24, 2
    s_add_u32 s35, s35, s3
    s_mul_i32 s36, s25, 96
    s_add_u32 s36, s36, 0
    s_lshr_b32 s37, s36, 9
    s_and_b32 s38, s36, 511
    s_lshr_b32 s38, s38, 4
    s_cmp_eq_u32 s37, 2
    s_cbranch_scc1 EV_l1_kernel_37
    s_cmp_eq_u32 s37, 0
    s_cselect_b32 s39, 0x3eb8aa3b, 1.0
    s_lshl_b32 s40, s37, 21
    s_lshl_b32 s41, s38, 6
    s_add_u32 s41, s41, s35
    s_lshl_b32 s41, s41, 10
    s_add_u32 s40, s40, s41
    v_mul_f32 v16, s39, v16
    v_mul_f32 v17, s39, v17
    v_mul_f32 v18, s39, v18
    v_mul_f32 v19, s39, v19
    v_mul_f32 v20, s39, v20
    v_mul_f32 v21, s39, v21
    v_mul_f32 v22, s39, v22
    v_mul_f32 v23, s39, v23
    v_mul_f32 v24, s39, v24
    v_mul_f32 v25, s39, v25
    v_mul_f32 v26, s39, v26
    v_mul_f32 v27, s39, v27
    v_mul_f32 v28, s39, v28
    v_mul_f32 v29, s39, v29
    v_mul_f32 v30, s39, v30
    v_mul_f32 v31, s39, v31
    v_cvt_pk_bf16_f32 v88, v16, v17
    v_cvt_pk_bf16_f32 v89, v18, v19
    v_cvt_pk_bf16_f32 v90, v20, v21
    v_cvt_pk_bf16_f32 v91, v22, v23
    v_cvt_pk_bf16_f32 v92, v24, v25
    v_cvt_pk_bf16_f32 v93, v26, v27
    v_cvt_pk_bf16_f32 v94, v28, v29
    v_cvt_pk_bf16_f32 v95, v30, v31
    buffer_store_dwordx4 v[88:91], v2, s[20:23], s40 offen
    s_add_u32 s40, s40, 65536
    buffer_store_dwordx4 v[92:95], v2, s[20:23], s40 offen
    s_cmp_lg_u32 s37, 1
    s_cbranch_scc1 EN_l1_kernel_38
    v_mul_f32 v96, v16, v16
    v_fmac_f32 v96, v17, v17
    v_fmac_f32 v96, v18, v18
    v_fmac_f32 v96, v19, v19
    v_fmac_f32 v96, v20, v20
    v_fmac_f32 v96, v21, v21
    v_fmac_f32 v96, v22, v22
    v_fmac_f32 v96, v23, v23
    v_mul_f32 v97, v24, v24
    v_fmac_f32 v97, v25, v25
    v_fmac_f32 v97, v26, v26
    v_fmac_f32 v97, v27, v27
    v_fmac_f32 v97, v28, v28
    v_fmac_f32 v97, v29, v29
    v_fmac_f32 v97, v30, v30
    v_fmac_f32 v97, v31, v31
    v_mov_b32 v98, v96
    v_mov_b32 v99, v97
    s_nop 1
    v_permlane32_swap_b32 v96, v98
    v_permlane32_swap_b32 v97, v99
    s_nop 1
    v_add_f32 v96, v96, v98
    v_add_f32 v97, v97, v99
    s_nop 1
    v_max_f32_dpp v96, v96, v96 quad_perm:[1,0,3,2] row_mask:0xf bank_mask:0xf
    v_max_f32_dpp v97, v97, v97 quad_perm:[1,0,3,2] row_mask:0xf bank_mask:0xf
    s_nop 1
    v_max_f32_dpp v96, v96, v96 quad_perm:[2,3,0,1] row_mask:0xf bank_mask:0xf
    v_max_f32_dpp v97, v97, v97 quad_perm:[2,3,0,1] row_mask:0xf bank_mask:0xf
    s_nop 1
    v_max_f32_dpp v96, v96, v96 row_half_mirror row_mask:0xf bank_mask:0xf
    v_max_f32_dpp v97, v97, v97 row_half_mirror row_mask:0xf bank_mask:0xf
    s_nop 1
    v_max_f32_dpp v96, v96, v96 row_mirror row_mask:0xf bank_mask:0xf
    v_max_f32_dpp v97, v97, v97 row_mirror row_mask:0xf bank_mask:0xf
    v_mov_b32 v98, v96
    v_mov_b32 v99, v97
    s_nop 1
    v_permlane16_swap_b32 v96, v98
    v_permlane16_swap_b32 v97, v99
    s_nop 1
    v_max_f32 v96, v96, v98
    v_max_f32 v97, v97, v99
    s_lshl_b32 s41, s38, 6
    s_add_u32 s41, s41, s35
    s_lshl_b32 s41, s41, 2
    s_add_u32 s41, s41, 8388608
    v_mov_b32 v100, 0
    s_mov_b64 exec, 1
    buffer_store_dword v96, v100, s[20:23], s41 offen
    buffer_store_dword v97, v100, s[20:23], s41 offen offset:256
    s_mov_b64 exec, -1
    s_branch EN_l1_kernel_38
EV_l1_kernel_37:
    s_lshl_b32 s40, s38, 16
    s_lshl_b32 s41, s35, 10
    s_add_u32 s40, s40, s41
    s_add_u32 s40, s40, 4194304
    v_cvt_pk_bf16_f32 v88, v16, v17
    v_cvt_pk_bf16_f32 v89, v18, v19
    v_cvt_pk_bf16_f32 v90, v20, v21
    v_cvt_pk_bf16_f32 v91, v22, v23
    v_cvt_pk_bf16_f32 v92, v24, v25
    v_cvt_pk_bf16_f32 v93, v26, v27
    v_cvt_pk_bf16_f32 v94, v28, v29
    v_cvt_pk_bf16_f32 v95, v30, v31
    buffer_store_dwordx4 v[88:91], v3, s[20:23], s40 offen
    buffer_store_dwordx4 v[92:95], v3, s[20:23], s40 offen offset:512
EN_l1_kernel_38:
    s_nop 3
    s_mul_i32 s36, s25, 96
    s_add_u32 s36, s36, 32
    s_lshr_b32 s37, s36, 9
    s_and_b32 s38, s36, 511
    s_lshr_b32 s38, s38, 4
    s_cmp_eq_u32 s37, 2
    s_cbranch_scc1 EV_l1_kernel_39
    s_cmp_eq_u32 s37, 0
    s_cselect_b32 s39, 0x3eb8aa3b, 1.0
    s_lshl_b32 s40, s37, 21
    s_lshl_b32 s41, s38, 6
    s_add_u32 s41, s41, s35
    s_lshl_b32 s41, s41, 10
    s_add_u32 s40, s40, s41
    v_mul_f32 v32, s39, v32
    v_mul_f32 v33, s39, v33
    v_mul_f32 v34, s39, v34
    v_mul_f32 v35, s39, v35
    v_mul_f32 v36, s39, v36
    v_mul_f32 v37, s39, v37
    v_mul_f32 v38, s39, v38
    v_mul_f32 v39, s39, v39
    v_mul_f32 v40, s39, v40
    v_mul_f32 v41, s39, v41
    v_mul_f32 v42, s39, v42
    v_mul_f32 v43, s39, v43
    v_mul_f32 v44, s39, v44
    v_mul_f32 v45, s39, v45
    v_mul_f32 v46, s39, v46
    v_mul_f32 v47, s39, v47
    v_cvt_pk_bf16_f32 v88, v32, v33
    v_cvt_pk_bf16_f32 v89, v34, v35
    v_cvt_pk_bf16_f32 v90, v36, v37
    v_cvt_pk_bf16_f32 v91, v38, v39
    v_cvt_pk_bf16_f32 v92, v40, v41
    v_cvt_pk_bf16_f32 v93, v42, v43
    v_cvt_pk_bf16_f32 v94, v44, v45
    v_cvt_pk_bf16_f32 v95, v46, v47
    buffer_store_dwordx4 v[88:91], v2, s[20:23], s40 offen
    s_add_u32 s40, s40, 65536
    buffer_store_dwordx4 v[92:95], v2, s[20:23], s40 offen
    s_cmp_lg_u32 s37, 1
    s_cbranch_scc1 EN_l1_kernel_40
    v_mul_f32 v96, v32, v32
    v_fmac_f32 v96, v33, v33
    v_fmac_f32 v96, v34, v34
    v_fmac_f32 v96, v35, v35
    v_fmac_f32 v96, v36, v36
    v_fmac_f32 v96, v37, v37
    v_fmac_f32 v96, v38, v38
    v_fmac_f32 v96, v39, v39
    v_mul_f32 v97, v40, v40
    v_fmac_f32 v97, v41, v41
    v_fmac_f32 v97, v42, v42
    v_fmac_f32 v97, v43, v43
    v_fmac_f32 v97, v44, v44
    v_fmac_f32 v97, v45, v45
    v_fmac_f32 v97, v46, v46
    v_fmac_f32 v97, v47, v47
    v_mov_b32 v98, v96
    v_mov_b32 v99, v97
    s_nop 1
    v_permlane32_swap_b32 v96, v98
    v_permlane32_swap_b32 v97, v99
    s_nop 1
    v_add_f32 v96, v96, v98
    v_add_f32 v97, v97, v99
    s_nop 1
    v_max_f32_dpp v96, v96, v96 quad_perm:[1,0,3,2] row_mask:0xf bank_mask:0xf
    v_max_f32_dpp v97, v97, v97 quad_perm:[1,0,3,2] row_mask:0xf bank_mask:0xf
    s_nop 1
    v_max_f32_dpp v96, v96, v96 quad_perm:[2,3,0,1] row_mask:0xf bank_mask:0xf
    v_max_f32_dpp v97, v97, v97 quad_perm:[2,3,0,1] row_mask:0xf bank_mask:0xf
    s_nop 1
    v_max_f32_dpp v96, v96, v96 row_half_mirror row_mask:0xf bank_mask:0xf
    v_max_f32_dpp v97, v97, v97 row_half_mirror row_mask:0xf bank_mask:0xf
    s_nop 1
    v_max_f32_dpp v96, v96, v96 row_mirror row_mask:0xf bank_mask:0xf
    v_max_f32_dpp v97, v97, v97 row_mirror row_mask:0xf bank_mask:0xf
    v_mov_b32 v98, v96
    v_mov_b32 v99, v97
    s_nop 1
    v_permlane16_swap_b32 v96, v98
    v_permlane16_swap_b32 v97, v99
    s_nop 1
    v_max_f32 v96, v96, v98
    v_max_f32 v97, v97, v99
    s_lshl_b32 s41, s38, 6
    s_add_u32 s41, s41, s35
    s_lshl_b32 s41, s41, 2
    s_add_u32 s41, s41, 8388608
    v_mov_b32 v100, 0
    s_mov_b64 exec, 1
    buffer_store_dword v96, v100, s[20:23], s41 offen
    buffer_store_dword v97, v100, s[20:23], s41 offen offset:256
    s_mov_b64 exec, -1
    s_branch EN_l1_kernel_40
EV_l1_kernel_39:
    s_lshl_b32 s40, s38, 16
    s_lshl_b32 s41, s35, 10
    s_add_u32 s40, s40, s41
    s_add_u32 s40, s40, 4194304
    v_cvt_pk_bf16_f32 v88, v32, v33
    v_cvt_pk_bf16_f32 v89, v34, v35
    v_cvt_pk_bf16_f32 v90, v36, v37
    v_cvt_pk_bf16_f32 v91, v38, v39
    v_cvt_pk_bf16_f32 v92, v40, v41
    v_cvt_pk_bf16_f32 v93, v42, v43
    v_cvt_pk_bf16_f32 v94, v44, v45
    v_cvt_pk_bf16_f32 v95, v46, v47
    buffer_store_dwordx4 v[88:91], v3, s[20:23], s40 offen
    buffer_store_dwordx4 v[92:95], v3, s[20:23], s40 offen offset:512
EN_l1_kernel_40:
    s_nop 3
    s_mul_i32 s36, s25, 96
    s_add_u32 s36, s36, 64
    s_lshr_b32 s37, s36, 9
    s_and_b32 s38, s36, 511
    s_lshr_b32 s38, s38, 4
    s_cmp_eq_u32 s37, 2
    s_cbranch_scc1 EV_l1_kernel_41
    s_cmp_eq_u32 s37, 0
    s_cselect_b32 s39, 0x3eb8aa3b, 1.0
    s_lshl_b32 s40, s37, 21
    s_lshl_b32 s41, s38, 6
    s_add_u32 s41, s41, s35
    s_lshl_b32 s41, s41, 10
    s_add_u32 s40, s40, s41
    v_mul_f32 v48, s39, v48
    v_mul_f32 v49, s39, v49
    v_mul_f32 v50, s39, v50
    v_mul_f32 v51, s39, v51
    v_mul_f32 v52, s39, v52
    v_mul_f32 v53, s39, v53
    v_mul_f32 v54, s39, v54
    v_mul_f32 v55, s39, v55
    v_mul_f32 v56, s39, v56
    v_mul_f32 v57, s39, v57
    v_mul_f32 v58, s39, v58
    v_mul_f32 v59, s39, v59
    v_mul_f32 v60, s39, v60
    v_mul_f32 v61, s39, v61
    v_mul_f32 v62, s39, v62
    v_mul_f32 v63, s39, v63
    v_cvt_pk_bf16_f32 v88, v48, v49
    v_cvt_pk_bf16_f32 v89, v50, v51
    v_cvt_pk_bf16_f32 v90, v52, v53
    v_cvt_pk_bf16_f32 v91, v54, v55
    v_cvt_pk_bf16_f32 v92, v56, v57
    v_cvt_pk_bf16_f32 v93, v58, v59
    v_cvt_pk_bf16_f32 v94, v60, v61
    v_cvt_pk_bf16_f32 v95, v62, v63
    buffer_store_dwordx4 v[88:91], v2, s[20:23], s40 offen
    s_add_u32 s40, s40, 65536
    buffer_store_dwordx4 v[92:95], v2, s[20:23], s40 offen
    s_cmp_lg_u32 s37, 1
    s_cbranch_scc1 EN_l1_kernel_42
    v_mul_f32 v96, v48, v48
    v_fmac_f32 v96, v49, v49
    v_fmac_f32 v96, v50, v50
    v_fmac_f32 v96, v51, v51
    v_fmac_f32 v96, v52, v52
    v_fmac_f32 v96, v53, v53
    v_fmac_f32 v96, v54, v54
    v_fmac_f32 v96, v55, v55
    v_mul_f32 v97, v56, v56
    v_fmac_f32 v97, v57, v57
    v_fmac_f32 v97, v58, v58
    v_fmac_f32 v97, v59, v59
    v_fmac_f32 v97, v60, v60
    v_fmac_f32 v97, v61, v61
    v_fmac_f32 v97, v62, v62
    v_fmac_f32 v97, v63, v63
    v_mov_b32 v98, v96
    v_mov_b32 v99, v97
    s_nop 1
    v_permlane32_swap_b32 v96, v98
    v_permlane32_swap_b32 v97, v99
    s_nop 1
    v_add_f32 v96, v96, v98
    v_add_f32 v97, v97, v99
    s_nop 1
    v_max_f32_dpp v96, v96, v96 quad_perm:[1,0,3,2] row_mask:0xf bank_mask:0xf
    v_max_f32_dpp v97, v97, v97 quad_perm:[1,0,3,2] row_mask:0xf bank_mask:0xf
    s_nop 1
    v_max_f32_dpp v96, v96, v96 quad_perm:[2,3,0,1] row_mask:0xf bank_mask:0xf
    v_max_f32_dpp v97, v97, v97 quad_perm:[2,3,0,1] row_mask:0xf bank_mask:0xf
    s_nop 1
    v_max_f32_dpp v96, v96, v96 row_half_mirror row_mask:0xf bank_mask:0xf
    v_max_f32_dpp v97, v97, v97 row_half_mirror row_mask:0xf bank_mask:0xf
    s_nop 1
    v_max_f32_dpp v96, v96, v96 row_mirror row_mask:0xf bank_mask:0xf
    v_max_f32_dpp v97, v97, v97 row_mirror row_mask:0xf bank_mask:0xf
    v_mov_b32 v98, v96
    v_mov_b32 v99, v97
    s_nop 1
    v_permlane16_swap_b32 v96, v98
    v_permlane16_swap_b32 v97, v99
    s_nop 1
    v_max_f32 v96, v96, v98
    v_max_f32 v97, v97, v99
    s_lshl_b32 s41, s38, 6
    s_add_u32 s41, s41, s35
    s_lshl_b32 s41, s41, 2
    s_add_u32 s41, s41, 8388608
    v_mov_b32 v100, 0
    s_mov_b64 exec, 1
    buffer_store_dword v96, v100, s[20:23], s41 offen
    buffer_store_dword v97, v100, s[20:23], s41 offen offset:256
    s_mov_b64 exec, -1
    s_branch EN_l1_kernel_42
EV_l1_kernel_41:
    s_lshl_b32 s40, s38, 16
    s_lshl_b32 s41, s35, 10
    s_add_u32 s40, s40, s41
    s_add_u32 s40, s40, 4194304
    v_cvt_pk_bf16_f32 v88, v48, v49
    v_cvt_pk_bf16_f32 v89, v50, v51
    v_cvt_pk_bf16_f32 v90, v52, v53
    v_cvt_pk_bf16_f32 v91, v54, v55
    v_cvt_pk_bf16_f32 v92, v56, v57
    v_cvt_pk_bf16_f32 v93, v58, v59
    v_cvt_pk_bf16_f32 v94, v60, v61
    v_cvt_pk_bf16_f32 v95, v62, v63
    buffer_store_dwordx4 v[88:91], v3, s[20:23], s40 offen
    buffer_store_dwordx4 v[92:95], v3, s[20:23], s40 offen offset:512
EN_l1_kernel_42:
    s_nop 3
    s_endpgm
SECOND_l1_kernel_1:
    s_load_dwordx4 s[56:59], s[0:1], 0
    s_load_dwordx4 s[60:63], s[0:1], 16
    s_load_dwordx4 s[64:67], s[0:1], 32
    s_load_dwordx2 s[70:71], s[0:1], 96
    v_mov_b32 v1, v0
    v_lshrrev_b32 v2, 6, v0
    v_and_b32 v0, 63, v0
    s_nop 0
    v_readfirstlane_b32 s3, v2
    s_and_b32 s24, s2, 7
    s_lshl_b32 s24, s24, 5
    s_lshr_b32 s25, s2, 3
    s_add_u32 s24, s24, s25
    s_lshl_b32 s24, s24, 1
    s_lshl_b32 s25, s24, 1
    s_waitcnt lgkmcnt(0)
    s_mov_b32 s12, s56
    s_and_b32 s13, s57, 0xffff
    s_mov_b32 s14, 2097152
    s_mov_b32 s15, 0x00020000
    s_mov_b32 s16, s58
    s_and_b32 s17, s59, 0xffff
    s_mov_b32 s18, 131072
    s_mov_b32 s19, 0x00020000
    s_mov_b32 s20, s60
    s_and_b32 s21, s61, 0xffff
    s_mov_b32 s22, 131072
    s_mov_b32 s23, 0x00020000
    s_mov_b32 s40, s62
    s_and_b32 s41, s63, 0xffff
    s_mov_b32 s42, 131072
    s_mov_b32 s43, 0x00020000
    s_mov_b32 s44, s64
    s_and_b32 s45, s65, 0xffff
    s_mov_b32 s46, 131072
    s_mov_b32 s47, 0x00020000
    s_mov_b32 s48, s70
    s_and_b32 s49, s71, 0xffff
    s_mov_b32 s50, 13631488
    s_mov_b32 s51, 0x00020000
    s_add_u32 s66, s66, s25
    s_addc_u32 s67, s67, 0
    s_load_dword s52, s[66:67], 0
    s_lshr_b32 s26, s3, 1
    s_and_b32 s27, s3, 1
    s_add_u32 s28, s24, s26
    s_lshl_b32 s28, s28, 8
    s_lshl_b32 s29, s27, 7
    s_add_u32 s28, s28, s29
    v_lshrrev_b32 v5, 4, v0
    v_lshlrev_b32 v5, 5, v5
    v_add_u32 v5, s28, v5
    buffer_load_dwordx4 v[64:67], v5, s[16:19], 0 offen
    buffer_load_dwordx4 v[68:71], v5, s[16:19], 0 offen offset:16
    buffer_load_dwordx4 v[72:75], v5, s[20:23], 0 offen
    buffer_load_dwordx4 v[76:79], v5, s[20:23], 0 offen offset:16
    buffer_load_dwordx4 v[80:83], v5, s[40:43], 0 offen
    buffer_load_dwordx4 v[84:87], v5, s[40:43], 0 offen offset:16
    buffer_load_dwordx4 v[88:91], v5, s[44:47], 0 offen
    buffer_load_dwordx4 v[92:95], v5, s[44:47], 0 offen offset:16
    s_lshr_b32 s30, s2, 3
    s_and_b32 s31, s2, 7
    v_lshrrev_b32 v3, 2, v1
    s_lshl_b32 s32, s30, 6
    v_add_u32 v4, s32, v3
    v_lshlrev_b32 v4, 10, v4
    v_and_b32 v16, 3, v1
    v_lshlrev_b32 v16, 5, v16
    v_add_u32 v4, v4, v16
    s_lshl_b32 s32, s31, 7
    buffer_load_dwordx4 v[200:203], v4, s[12:15], s32 offen
    buffer_load_dwordx4 v[204:207], v4, s[12:15], s32 offen offset:16
    v_mul_u32_u24 v3, 192, v3
    v_add_u32 v3, v3, v16
    v_and_b32 v14, 15, v0
    v_lshlrev_b32 v6, 3, v14
    v_cvt_f32_u32 v6, v6
    v_mov_b32 v7, v6
    v_lshrrev_b32 v16, 3, v14
    v_lshlrev_b32 v16, 7, v16
    v_and_b32 v17, 7, v14
    v_add_u32 v16, v16, v17
    v_cvt_f32_u32 v8, v16
    v_mov_b32 v9, v8
    v_lshlrev_b32 v15, 1, v14
    v_add_u32 v15, 16, v15
    v_lshlrev_b32 v18, 2, v14
    v_cmp_gt_u32 vcc, 8, v14
    s_nop 1
    v_cndmask_b32 v15, v18, v15, vcc
    v_lshrrev_b32 v16, 3, v15
    v_lshlrev_b32 v16, 7, v16
    v_and_b32 v17, 7, v15
    v_add_u32 v16, v16, v17
    v_cvt_f32_u32 v10, v16
    v_mov_b32 v11, v10
    v_lshlrev_b32 v15, 3, v14
    v_add_u32 v15, 64, v15
    v_lshrrev_b32 v16, 3, v15
    v_lshlrev_b32 v16, 7, v16
    v_and_b32 v17, 7, v15
    v_add_u32 v16, v16, v17
    v_cvt_f32_u32 v12, v16
    v_mov_b32 v13, v12
    v_lshlrev_b32 v186, 4, v1
    v_lshlrev_b32 v20, 3, v1
    v_sub_u32 v20, 2047, v20
    s_mov_b32 s37, 0
IX_l1_kernel_43:
    v_cvt_f32_u32 v21, v20
    v_cvt_pk_bf16_f32 v21, v21, v21
    v_lshlrev_b32 v21, 16, v21
    v_cvt_u32_f32 v21, v21
    v_lshrrev_b32 v22, 7, v21
    v_lshlrev_b32 v22, 3, v22
    v_and_b32 v23, 7, v21
    v_or_b32 v22, v22, v23
    v_or_b32 v23, 8, v22
    v_ffbh_u32 v23, v23
    v_sub_u32 v23, 28, v23
    v_lshrrev_b32 v22, v23, v22
    v_lshlrev_b32 v23, 3, v23
    v_add_u32 v22, v22, v23
    v_lshrrev_b32 v23, 3, v21
    v_and_b32 v23, 15, v23
    v_lshlrev_b32 v22, 4, v22
    v_add_u32 v22, v22, v23
    v_lshlrev_b32 v22, 2, v22
    s_set_gpr_idx_on s37, gpr_idx(DST)
    s_nop 0
    v_mov_b32 v176, v22
    s_set_gpr_idx_off
    v_subrev_u32 v20, 1, v20
    s_add_u32 s37, s37, 1
    s_cmp_lt_u32 s37, 8
    s_cbranch_scc1 IX_l1_kernel_43
    s_waitcnt lgkmcnt(0)
    s_lshl_b32 s53, s52, 16
    s_and_b32 s55, s52, 0xffff0000
    s_cmp_eq_u32 s26, 0
    s_cselect_b32 s53, s53, s55
    v_mov_b32 v15, s53
    v_mul_f32 v15, 0x3fb8aa3b, v15
    v_exp_f32 v15, v15
    s_nop 0
    v_cvt_pk_bf16_f32 v15, v15, v15
    v_lshlrev_b32 v15, 16, v15
    s_mov_b32 s34, 0x3fb8aa3b
    s_mov_b32 s35, 0xbfb8aa3b
    s_mov_b32 s36, 0x3e22f983
    v_add_f32 v16, v15, v15
    s_waitcnt vmcnt(0)
    ds_write_b128 v3, v[200:203] offset:12288
    ds_write_b128 v3, v[204:207] offset:12304
    s_waitcnt lgkmcnt(0)
    s_barrier
    v_lshrrev_b32 v20, 2, v14
    s_lshl_b32 s37, s3, 4
    v_add_u32 v20, s37, v20
    v_mul_u32_u24 v20, 192, v20
    v_lshrrev_b32 v21, 4, v0
    v_lshlrev_b32 v21, 5, v21
    v_add_u32 v20, v20, v21
    v_and_b32 v21, 3, v0
    v_lshlrev_b32 v21, 3, v21
    v_add_u32 v20, v20, v21
    ds_read_b64_tr_b16 v[200:201], v20 offset:12288
    ds_read_b64_tr_b16 v[202:203], v20 offset:13056
    ds_read_b64_tr_b16 v[204:205], v20 offset:13824
    ds_read_b64_tr_b16 v[206:207], v20 offset:14592
    v_mul_u32_u24 v21, 144, v0
    s_lshl_b32 s38, s3, 5
    v_add_u32 v21, s38, v21
    s_waitcnt lgkmcnt(0)
    ds_write_b128 v21, v[200:203] offset:24576
    ds_write_b128 v21, v[204:207] offset:24592
    s_waitcnt lgkmcnt(0)
    s_barrier
    v_lshrrev_b32 v20, 2, v1
    v_mul_u32_u24 v21, 144, v20
    v_and_b32 v22, 3, v1
    v_lshlrev_b32 v22, 5, v22
    v_add_u32 v21, v21, v22
    ds_read_b128 v[200:203], v21 offset:24576
    ds_read_b128 v[204:207], v21 offset:24592
    v_lshlrev_b32 v20, 12, v20
    v_add_u32 v21, v20, v22
    s_lshl_b32 s37, s31, 18
    s_lshl_b32 s38, s30, 7
    s_add_u32 s37, s37, s38
    s_add_u32 s37, s37, 9437184
    s_waitcnt lgkmcnt(0)
    buffer_store_dwordx4 v[200:203], v21, s[48:51], s37 offen
    buffer_store_dwordx4 v[204:207], v21, s[48:51], s37 offen offset:16
    v_mov_b32 v160, 0
    v_mov_b32 v161, 0
    v_mov_b32 v162, 0
    v_mov_b32 v163, 0
    v_mov_b32 v164, 0
    v_mov_b32 v165, 0
    v_mov_b32 v166, 0
    v_mov_b32 v167, 0
    v_mov_b32 v168, 0
    v_mov_b32 v169, 0
    v_mov_b32 v170, 0
    v_mov_b32 v171, 0
    s_mov_b32 s37, 0
KG_l1_kernel_44:
    s_set_gpr_idx_on s37, gpr_idx(SRC0)
    s_nop 0
    v_mov_b32 v100, v64
    v_mov_b32 v101, v65
    v_mov_b32 v102, v72
    v_mov_b32 v103, v73
    v_mov_b32 v104, v80
    v_mov_b32 v105, v81
    v_mov_b32 v106, v88
    v_mov_b32 v107, v89
    s_set_gpr_idx_off
    v_lshlrev_b32 v96, 16, v100
    v_lshlrev_b32 v97, 16, v102
    v_lshlrev_b32 v98, 16, v104
    v_lshlrev_b32 v99, 16, v106
    v_mul_f32 v96, s34, v96
    v_mul_f32 v97, v97, v15
    v_exp_f32 v96, v96
    v_mul_f32 v98, v98, v16
    v_mul_f32 v99, v99, v16
    v_cvt_pk_bf16_f32 v96, v96, v96
    v_mul_f32 v97, s36, v97
    v_lshlrev_b32 v96, 16, v96
    v_mul_f32 v96, v96, v15
    v_mul_f32 v96, s35, v96
    v_pk_mul_f32 v[20:21], v[96:97], v[6:7]
    v_pk_mul_f32 v[22:23], v[96:97], v[8:9]
    v_pk_mul_f32 v[24:25], v[96:97], v[10:11]
    v_pk_mul_f32 v[26:27], v[96:97], v[12:13]
    v_exp_f32 v20, v20
    v_fract_f32 v21, v21
    v_exp_f32 v22, v22
    v_fract_f32 v23, v23
    v_exp_f32 v24, v24
    v_fract_f32 v25, v25
    v_exp_f32 v26, v26
    v_fract_f32 v27, v27
    v_cos_f32 v28, v21
    v_sin_f32 v29, v21
    v_cos_f32 v30, v23
    v_sin_f32 v31, v23
    v_cos_f32 v32, v25
    v_sin_f32 v33, v25
    v_cos_f32 v34, v27
    v_sin_f32 v35, v27
    s_nop 0
    v_pk_mul_f32 v[28:29], v[28:29], v[20:21] op_sel_hi:[1,0]
    v_pk_mul_f32 v[30:31], v[30:31], v[22:23] op_sel_hi:[1,0]
    v_pk_mul_f32 v[32:33], v[32:33], v[24:25] op_sel_hi:[1,0]
    v_pk_mul_f32 v[34:35], v[34:35], v[26:27] op_sel_hi:[1,0]
    v_cvt_pk_bf16_f32 v44, v30, v31
    v_cvt_pk_bf16_f32 v48, v32, v33
    v_cvt_pk_bf16_f32 v52, v34, v35
    v_mul_f32 v36, v99, v29
    v_mul_f32 v37, v99, v28
    v_fma_f32 v36, v98, v28, -v36
    v_fma_f32 v37, -v98, v29, -v37
    v_cvt_pk_bf16_f32 v40, v36, v37
    v_and_b32 v96, 0xffff0000, v100
    v_and_b32 v97, 0xffff0000, v102
    v_and_b32 v98, 0xffff0000, v104
    v_and_b32 v99, 0xffff0000, v106
    v_mul_f32 v96, s34, v96
    v_mul_f32 v97, v97, v15
    v_exp_f32 v96, v96
    v_mul_f32 v98, v98, v16
    v_mul_f32 v99, v99, v16
    v_cvt_pk_bf16_f32 v96, v96, v96
    v_mul_f32 v97, s36, v97
    v_lshlrev_b32 v96, 16, v96
    v_mul_f32 v96, v96, v15
    v_mul_f32 v96, s35, v96
    v_pk_mul_f32 v[20:21], v[96:97], v[6:7]
    v_pk_mul_f32 v[22:23], v[96:97], v[8:9]
    v_pk_mul_f32 v[24:25], v[96:97], v[10:11]
    v_pk_mul_f32 v[26:27], v[96:97], v[12:13]
    v_exp_f32 v20, v20
    v_fract_f32 v21, v21
    v_exp_f32 v22, v22
    v_fract_f32 v23, v23
    v_exp_f32 v24, v24
    v_fract_f32 v25, v25
    v_exp_f32 v26, v26
    v_fract_f32 v27, v27
    v_cos_f32 v28, v21
    v_sin_f32 v29, v21
    v_cos_f32 v30, v23
    v_sin_f32 v31, v23
    v_cos_f32 v32, v25
    v_sin_f32 v33, v25
    v_cos_f32 v34, v27
    v_sin_f32 v35, v27
    s_nop 0
    v_pk_mul_f32 v[28:29], v[28:29], v[20:21] op_sel_hi:[1,0]
    v_pk_mul_f32 v[30:31], v[30:31], v[22:23] op_sel_hi:[1,0]
    v_pk_mul_f32 v[32:33], v[32:33], v[24:25] op_sel_hi:[1,0]
    v_pk_mul_f32 v[34:35], v[34:35], v[26:27] op_sel_hi:[1,0]
    v_cvt_pk_bf16_f32 v45, v30, v31
    v_cvt_pk_bf16_f32 v49, v32, v33
    v_cvt_pk_bf16_f32 v53, v34, v35
    v_mul_f32 v36, v99, v29
    v_mul_f32 v37, v99, v28
    v_fma_f32 v36, v98, v28, -v36
    v_fma_f32 v37, -v98, v29, -v37
    v_cvt_pk_bf16_f32 v41, v36, v37
    v_lshlrev_b32 v96, 16, v101
    v_lshlrev_b32 v97, 16, v103
    v_lshlrev_b32 v98, 16, v105
    v_lshlrev_b32 v99, 16, v107
    v_mul_f32 v96, s34, v96
    v_mul_f32 v97, v97, v15
    v_exp_f32 v96, v96
    v_mul_f32 v98, v98, v16
    v_mul_f32 v99, v99, v16
    v_cvt_pk_bf16_f32 v96, v96, v96
    v_mul_f32 v97, s36, v97
    v_lshlrev_b32 v96, 16, v96
    v_mul_f32 v96, v96, v15
    v_mul_f32 v96, s35, v96
    v_pk_mul_f32 v[20:21], v[96:97], v[6:7]
    v_pk_mul_f32 v[22:23], v[96:97], v[8:9]
    v_pk_mul_f32 v[24:25], v[96:97], v[10:11]
    v_pk_mul_f32 v[26:27], v[96:97], v[12:13]
    v_exp_f32 v20, v20
    v_fract_f32 v21, v21
    v_exp_f32 v22, v22
    v_fract_f32 v23, v23
    v_exp_f32 v24, v24
    v_fract_f32 v25, v25
    v_exp_f32 v26, v26
    v_fract_f32 v27, v27
    v_cos_f32 v28, v21
    v_sin_f32 v29, v21
    v_cos_f32 v30, v23
    v_sin_f32 v31, v23
    v_cos_f32 v32, v25
    v_sin_f32 v33, v25
    v_cos_f32 v34, v27
    v_sin_f32 v35, v27
    s_nop 0
    v_pk_mul_f32 v[28:29], v[28:29], v[20:21] op_sel_hi:[1,0]
    v_pk_mul_f32 v[30:31], v[30:31], v[22:23] op_sel_hi:[1,0]
    v_pk_mul_f32 v[32:33], v[32:33], v[24:25] op_sel_hi:[1,0]
    v_pk_mul_f32 v[34:35], v[34:35], v[26:27] op_sel_hi:[1,0]
    v_cvt_pk_bf16_f32 v46, v30, v31
    v_cvt_pk_bf16_f32 v50, v32, v33
    v_cvt_pk_bf16_f32 v54, v34, v35
    v_mul_f32 v36, v99, v29
    v_mul_f32 v37, v99, v28
    v_fma_f32 v36, v98, v28, -v36
    v_fma_f32 v37, -v98, v29, -v37
    v_cvt_pk_bf16_f32 v42, v36, v37
    v_and_b32 v96, 0xffff0000, v101
    v_and_b32 v97, 0xffff0000, v103
    v_and_b32 v98, 0xffff0000, v105
    v_and_b32 v99, 0xffff0000, v107
    v_mul_f32 v96, s34, v96
    v_mul_f32 v97, v97, v15
    v_exp_f32 v96, v96
    v_mul_f32 v98, v98, v16
    v_mul_f32 v99, v99, v16
    v_cvt_pk_bf16_f32 v96, v96, v96
    v_mul_f32 v97, s36, v97
    v_lshlrev_b32 v96, 16, v96
    v_mul_f32 v96, v96, v15
    v_mul_f32 v96, s35, v96
    v_pk_mul_f32 v[20:21], v[96:97], v[6:7]
    v_pk_mul_f32 v[22:23], v[96:97], v[8:9]
    v_pk_mul_f32 v[24:25], v[96:97], v[10:11]
    v_pk_mul_f32 v[26:27], v[96:97], v[12:13]
    v_exp_f32 v20, v20
    v_fract_f32 v21, v21
    v_exp_f32 v22, v22
    v_fract_f32 v23, v23
    v_exp_f32 v24, v24
    v_fract_f32 v25, v25
    v_exp_f32 v26, v26
    v_fract_f32 v27, v27
    v_cos_f32 v28, v21
    v_sin_f32 v29, v21
    v_cos_f32 v30, v23
    v_sin_f32 v31, v23
    v_cos_f32 v32, v25
    v_sin_f32 v33, v25
    v_cos_f32 v34, v27
    v_sin_f32 v35, v27
    s_nop 0
    v_pk_mul_f32 v[28:29], v[28:29], v[20:21] op_sel_hi:[1,0]
    v_pk_mul_f32 v[30:31], v[30:31], v[22:23] op_sel_hi:[1,0]
    v_pk_mul_f32 v[32:33], v[32:33], v[24:25] op_sel_hi:[1,0]
    v_pk_mul_f32 v[34:35], v[34:35], v[26:27] op_sel_hi:[1,0]
    v_cvt_pk_bf16_f32 v47, v30, v31
    v_cvt_pk_bf16_f32 v51, v32, v33
    v_cvt_pk_bf16_f32 v55, v34, v35
    v_mul_f32 v36, v99, v29
    v_mul_f32 v37, v99, v28
    v_fma_f32 v36, v98, v28, -v36
    v_fma_f32 v37, -v98, v29, -v37
    v_cvt_pk_bf16_f32 v43, v36, v37
    s_add_u32 s37, s37, 2
    s_cmp_lt_u32 s37, 8
    v_mfma_f32_16x16x32_bf16 v[160:163], v[44:47], v[40:43], v[160:163]
    v_mfma_f32_16x16x32_bf16 v[164:167], v[48:51], v[40:43], v[164:167]
    v_mfma_f32_16x16x32_bf16 v[168:171], v[52:55], v[40:43], v[168:171]
    s_cbranch_scc1 KG_l1_kernel_44
    s_nop 7
    v_lshrrev_b32 v20, 4, v0
    v_lshlrev_b32 v20, 8, v20
    v_lshlrev_b32 v21, 2, v14
    v_add_u32 v20, v20, v21
    s_mul_i32 s37, s3, 3072
    v_add_u32 v20, s37, v20
    ds_write_b32 v20, v160 offset:0
    ds_write_b32 v20, v161 offset:64
    ds_write_b32 v20, v162 offset:128
    ds_write_b32 v20, v163 offset:192
    ds_write_b32 v20, v164 offset:1024
    ds_write_b32 v20, v165 offset:1088
    ds_write_b32 v20, v166 offset:1152
    ds_write_b32 v20, v167 offset:1216
    ds_write_b32 v20, v168 offset:2048
    ds_write_b32 v20, v169 offset:2112
    ds_write_b32 v20, v170 offset:2176
    ds_write_b32 v20, v171 offset:2240
    s_waitcnt lgkmcnt(0)
    s_barrier
    ds_read_b32 v16, v176 offset:0
    ds_read_b32 v64, v176 offset:3072
    ds_read_b32 v17, v177 offset:0
    ds_read_b32 v65, v177 offset:3072
    ds_read_b32 v18, v178 offset:0
    ds_read_b32 v66, v178 offset:3072
    ds_read_b32 v19, v179 offset:0
    ds_read_b32 v67, v179 offset:3072
    ds_read_b32 v20, v180 offset:0
    ds_read_b32 v68, v180 offset:3072
    ds_read_b32 v21, v181 offset:0
    ds_read_b32 v69, v181 offset:3072
    ds_read_b32 v22, v182 offset:0
    ds_read_b32 v70, v182 offset:3072
    ds_read_b32 v23, v183 offset:0
    ds_read_b32 v71, v183 offset:3072
    ds_read_b32 v24, v176 offset:6144
    ds_read_b32 v72, v176 offset:9216
    ds_read_b32 v25, v177 offset:6144
    ds_read_b32 v73, v177 offset:9216
    ds_read_b32 v26, v178 offset:6144
    ds_read_b32 v74, v178 offset:9216
    ds_read_b32 v27, v179 offset:6144
    ds_read_b32 v75, v179 offset:9216
    ds_read_b32 v28, v180 offset:6144
    ds_read_b32 v76, v180 offset:9216
    ds_read_b32 v29, v181 offset:6144
    ds_read_b32 v77, v181 offset:9216
    ds_read_b32 v30, v182 offset:6144
    ds_read_b32 v78, v182 offset:9216
    ds_read_b32 v31, v183 offset:6144
    ds_read_b32 v79, v183 offset:9216
    s_lshl_b32 s37, s24, 12
    s_add_u32 s37, s37, 11534336
    s_waitcnt lgkmcnt(0)
    v_add_f32 v16, v16, v64
    v_add_f32 v17, v17, v65
    v_add_f32 v18, v18, v66
    v_add_f32 v19, v19, v67
    v_add_f32 v20, v20, v68
    v_add_f32 v21, v21, v69
    v_add_f32 v22, v22, v70
    v_add_f32 v23, v23, v71
    v_add_f32 v24, v24, v72
    v_add_f32 v25, v25, v73
    v_add_f32 v26, v26, v74
    v_add_f32 v27, v27, v75
    v_add_f32 v28, v28, v76
    v_add_f32 v29, v29, v77
    v_add_f32 v30, v30, v78
    v_add_f32 v31, v31, v79
    v_cvt_pk_bf16_f32 v32, v16, v17
    v_cvt_pk_bf16_f32 v33, v18, v19
    v_cvt_pk_bf16_f32 v34, v20, v21
    v_cvt_pk_bf16_f32 v35, v22, v23
    v_cvt_pk_bf16_f32 v36, v24, v25
    v_cvt_pk_bf16_f32 v37, v26, v27
    v_cvt_pk_bf16_f32 v38, v28, v29
    v_cvt_pk_bf16_f32 v39, v30, v31
    buffer_store_dwordx4 v[32:35], v186, s[48:51], s37 offen
    s_add_u32 s37, s37, 4096
    buffer_store_dwordx4 v[36:39], v186, s[48:51], s37 offen
l1_kernel_end:
    s_endpgm
.globl l2_kernel
.p2align 8
.type l2_kernel,@function
l2_kernel:
    s_cmp_ge_u32 s2, 512
    s_cbranch_scc1 l2_kernel_end
    s_cmp_ge_u32 s2, 256
    s_cbranch_scc1 CONV_l2_kernel_1
    s_load_dwordx2 s[8:9], s[0:1], 96
    v_lshrrev_b32 v1, 6, v0
    v_and_b32 v0, 63, v0
    s_nop 0
    v_readfirstlane_b32 s3, v1
    s_and_b32 s24, s2, 7
    s_lshl_b32 s24, s24, 2
    s_lshr_b32 s25, s2, 3
    s_and_b32 s25, s25, 3
    s_add_u32 s24, s24, s25
    s_lshr_b32 s25, s2, 5
    s_waitcnt lgkmcnt(0)
    s_mov_b32 s20, s8
    s_and_b32 s21, s9, 0xffff
    s_mov_b32 s22, 13631488
    s_mov_b32 s23, 0x00020000
    v_lshlrev_b32 v2, 4, v0
    s_lshl_b32 s26, s25, 3
    s_add_u32 s26, s26, s3
    s_lshl_b32 s27, s24, 6
    s_add_u32 s27, s27, s26
    s_lshl_b32 s27, s27, 10
    buffer_load_dwordx4 v[4:7], v2, s[20:23], s27 offen
    v_lshlrev_b32 v8, 2, v0
    s_lshl_b32 s28, s24, 8
    s_add_u32 s28, s28, 8388608
    buffer_load_dword v11, v8, s[20:23], s28 offen
    s_lshl_b32 s28, s24, 16
    s_lshl_b32 s29, s3, 11
    s_add_u32 s31, s29, s28
    s_add_u32 s31, s31, 2097152
    s_mov_b32 s30, s29
    s_mov_b32 s38, 0
DMA_l2_kernel_2:
    s_add_u32 s39, s30, 0
    s_mov_b32 m0, s39
    s_add_u32 s40, s31, 0
    buffer_load_dwordx4 v2, s[20:23], s40 offen lds
    s_add_u32 s39, s30, 1024
    s_mov_b32 m0, s39
    s_add_u32 s40, s31, 1024
    buffer_load_dwordx4 v2, s[20:23], s40 offen lds
    s_add_u32 s30, s30, 16384
    s_add_u32 s31, s31, 16384
    s_add_u32 s38, s38, 1
    s_cmp_lt_u32 s38, 4
    s_cbranch_scc1 DMA_l2_kernel_2
    v_and_b32 v3, 15, v0
    v_lshlrev_b32 v3, 4, v3
    v_lshrrev_b32 v8, 5, v0
    v_lshlrev_b32 v8, 8, v8
    v_add_u32 v3, v3, v8
    v_and_b32 v8, 31, v0
    v_cmp_eq_u32 s[32:33], 16, v8
    v_cmp_eq_u32 s[34:35], 20, v8
    s_or_b64 s[32:33], s[32:33], s[34:35]
    v_mov_b32 v9, 0x3f803f80
    s_nop 0
    v_cndmask_b32 v9, 0, v9, s[32:33]
    v_mov_b32 v96, v9
    v_mov_b32 v97, v9
    v_mov_b32 v98, v9
    v_mov_b32 v99, v9
    v_mov_b32 v100, v9
    v_mov_b32 v101, v9
    v_mov_b32 v102, v9
    v_mov_b32 v103, v9
    v_mov_b32 v104, v9
    v_mov_b32 v105, v9
    v_mov_b32 v106, v9
    v_mov_b32 v107, v9
    v_mov_b32 v108, v9
    v_mov_b32 v109, v9
    v_mov_b32 v110, v9
    v_mov_b32 v111, v9
    v_mov_b32 v112, v9
    v_mov_b32 v113, v9
    v_mov_b32 v114, v9
    v_mov_b32 v115, v9
    v_mov_b32 v116, v9
    v_mov_b32 v117, v9
    v_mov_b32 v118, v9
    v_mov_b32 v119, v9
    v_mov_b32 v120, v9
    v_mov_b32 v121, v9
    v_mov_b32 v122, v9
    v_mov_b32 v123, v9
    v_mov_b32 v124, v9
    v_mov_b32 v125, v9
    v_mov_b32 v126, v9
    v_mov_b32 v127, v9
    s_mov_b32 s36, 0x0000ffff
    s_mov_b32 s37, 0x0000ffff
    s_add_u32 s44, s28, 4194304
    s_mov_b32 s43, s44
    s_mov_b64 exec, s[36:37]
    buffer_load_dwordx4 v[96:99], v3, s[20:23], s43 offen
    buffer_load_dwordx4 v[100:103], v3, s[20:23], s43 offen offset:512
    s_mov_b64 exec, -1
    s_add_u32 s43, s43, 1024
    s_mov_b64 exec, s[36:37]
    buffer_load_dwordx4 v[104:107], v3, s[20:23], s43 offen
    buffer_load_dwordx4 v[108:111], v3, s[20:23], s43 offen offset:512
    s_mov_b64 exec, -1
    s_add_u32 s43, s43, 1024
    s_mov_b64 exec, s[36:37]
    buffer_load_dwordx4 v[112:115], v3, s[20:23], s43 offen
    buffer_load_dwordx4 v[116:119], v3, s[20:23], s43 offen offset:512
    s_mov_b64 exec, -1
    s_add_u32 s43, s43, 1024
    s_waitcnt vmcnt(14)
    v_mov_b32 v12, 0
    v_dot2c_f32_bf16 v12, v4, v4
    v_dot2c_f32_bf16 v12, v5, v5
    v_dot2c_f32_bf16 v12, v6, v6
    v_dot2c_f32_bf16 v12, v7, v7
    s_nop 1
    v_max_f32_dpp v11, v11, v11 quad_perm:[1,0,3,2] row_mask:0xf bank_mask:0xf
    s_nop 1
    v_max_f32_dpp v11, v11, v11 quad_perm:[2,3,0,1] row_mask:0xf bank_mask:0xf
    s_nop 1
    v_max_f32_dpp v11, v11, v11 row_half_mirror row_mask:0xf bank_mask:0xf
    s_nop 1
    v_max_f32_dpp v11, v11, v11 row_mirror row_mask:0xf bank_mask:0xf
    v_mov_b32 v13, v11
    v_mov_b32 v14, v12
    s_nop 1
    v_permlane16_swap_b32 v11, v13
    v_permlane32_swap_b32 v12, v14
    s_nop 1
    v_max_f32 v11, v11, v13
    v_add_f32 v12, v12, v14
    v_mov_b32 v13, v11
    s_nop 1
    v_permlane32_swap_b32 v11, v13
    s_nop 1
    v_max_f32 v11, v11, v13
    v_mul_f32 v12, v12, v11
    v_sqrt_f32 v12, v12
    s_nop 0
    v_mul_f32 v15, 0xbf8147ae, v12
    v_mov_b32 v48, v15
    v_mov_b32 v49, v15
    v_mov_b32 v50, v15
    v_mov_b32 v51, v15
    v_mov_b32 v52, v15
    v_mov_b32 v53, v15
    v_mov_b32 v54, v15
    v_mov_b32 v55, v15
    v_mov_b32 v56, v15
    v_mov_b32 v57, v15
    v_mov_b32 v58, v15
    v_mov_b32 v59, v15
    v_mov_b32 v60, v15
    v_mov_b32 v61, v15
    v_mov_b32 v62, v15
    v_mov_b32 v63, v15
    s_mov_b32 s41, 63
    s_waitcnt vmcnt(12)
    s_barrier
P2S_l2_kernel_3:
    v_mov_b32 v64, 0
    v_mov_b32 v65, 0
    v_mov_b32 v66, 0
    v_mov_b32 v67, 0
    v_mov_b32 v68, 0
    v_mov_b32 v69, 0
    v_mov_b32 v70, 0
    v_mov_b32 v71, 0
    v_mov_b32 v72, 0
    v_mov_b32 v73, 0
    v_mov_b32 v74, 0
    v_mov_b32 v75, 0
    v_mov_b32 v76, 0
    v_mov_b32 v77, 0
    v_mov_b32 v78, 0
    v_mov_b32 v79, 0
    v_mov_b32 v10, v2
    ds_read_b128 v[80:83], v10
    s_waitcnt lgkmcnt(0)
    v_mfma_f32_32x32x16_bf16 v[16:31], v[80:83], v[4:7], v[48:63]
    ds_read_b128 v[84:87], v10 offset:1024
    s_nop 9
    s_mov_b32 s38, 0
P2_l2_kernel_5:
    s_and_b32 s39, s38, s41
    s_cmp_eq_u32 s39, 4
    s_cbranch_scc1 BB_l2_kernel_7
NB_l2_kernel_6:
    s_waitcnt lgkmcnt(0)
    v_mfma_f32_32x32x16_bf16 v[32:47], v[84:87], v[4:7], v[48:63]
    ds_read_b128 v[80:83], v10 offset:2048
    s_mov_b64 exec, s[36:37]
    buffer_load_dwordx4 v[120:123], v3, s[20:23], s43 offen
    buffer_load_dwordx4 v[124:127], v3, s[20:23], s43 offen offset:512
    s_mov_b64 exec, -1
    s_add_u32 s43, s43, 1024
    v_exp_f32 v16, v16
    v_exp_f32 v17, v17
    v_exp_f32 v18, v18
    v_exp_f32 v19, v19
    v_exp_f32 v20, v20
    v_exp_f32 v21, v21
    v_exp_f32 v22, v22
    v_exp_f32 v23, v23
    v_exp_f32 v24, v24
    v_exp_f32 v25, v25
    v_exp_f32 v26, v26
    v_exp_f32 v27, v27
    v_cvt_pk_bf16_f32 v88, v16, v17
    v_cvt_pk_bf16_f32 v89, v18, v19
    v_cvt_pk_bf16_f32 v90, v20, v21
    v_cvt_pk_bf16_f32 v91, v22, v23
    v_exp_f32 v28, v28
    v_exp_f32 v29, v29
    v_exp_f32 v30, v30
    v_exp_f32 v31, v31
    s_waitcnt vmcnt(6)
    v_mfma_f32_32x32x16_bf16 v[64:79], v[96:99], v[88:91], v[64:79]
    v_cvt_pk_bf16_f32 v92, v24, v25
    v_cvt_pk_bf16_f32 v93, v26, v27
    v_cvt_pk_bf16_f32 v94, v28, v29
    v_cvt_pk_bf16_f32 v95, v30, v31
    s_nop 1
    v_mfma_f32_32x32x16_bf16 v[64:79], v[100:103], v[92:95], v[64:79]
    s_waitcnt lgkmcnt(0)
    v_mfma_f32_32x32x16_bf16 v[16:31], v[80:83], v[4:7], v[48:63]
    ds_read_b128 v[84:87], v10 offset:3072
    s_mov_b64 exec, s[36:37]
    buffer_load_dwordx4 v[96:99], v3, s[20:23], s43 offen
    buffer_load_dwordx4 v[100:103], v3, s[20:23], s43 offen offset:512
    s_mov_b64 exec, -1
    s_add_u32 s43, s43, 1024
    v_exp_f32 v32, v32
    v_exp_f32 v33, v33
    v_exp_f32 v34, v34
    v_exp_f32 v35, v35
    v_exp_f32 v36, v36
    v_exp_f32 v37, v37
    v_exp_f32 v38, v38
    v_exp_f32 v39, v39
    v_exp_f32 v40, v40
    v_exp_f32 v41, v41
    v_exp_f32 v42, v42
    v_exp_f32 v43, v43
    v_cvt_pk_bf16_f32 v88, v32, v33
    v_cvt_pk_bf16_f32 v89, v34, v35
    v_cvt_pk_bf16_f32 v90, v36, v37
    v_cvt_pk_bf16_f32 v91, v38, v39
    v_exp_f32 v44, v44
    v_exp_f32 v45, v45
    v_exp_f32 v46, v46
    v_exp_f32 v47, v47
    s_waitcnt vmcnt(6)
    v_mfma_f32_32x32x16_bf16 v[64:79], v[104:107], v[88:91], v[64:79]
    v_cvt_pk_bf16_f32 v92, v40, v41
    v_cvt_pk_bf16_f32 v93, v42, v43
    v_cvt_pk_bf16_f32 v94, v44, v45
    v_cvt_pk_bf16_f32 v95, v46, v47
    s_nop 1
    v_mfma_f32_32x32x16_bf16 v[64:79], v[108:111], v[92:95], v[64:79]
    s_waitcnt lgkmcnt(0)
    v_mfma_f32_32x32x16_bf16 v[32:47], v[84:87], v[4:7], v[48:63]
    ds_read_b128 v[80:83], v10 offset:4096
    s_mov_b64 exec, s[36:37]
    buffer_load_dwordx4 v[104:107], v3, s[20:23], s43 offen
    buffer_load_dwordx4 v[108:111], v3, s[20:23], s43 offen offset:512
    s_mov_b64 exec, -1
    s_add_u32 s43, s43, 1024
    v_exp_f32 v16, v16
    v_exp_f32 v17, v17
    v_exp_f32 v18, v18
    v_exp_f32 v19, v19
    v_exp_f32 v20, v20
    v_exp_f32 v21, v21
    v_exp_f32 v22, v22
    v_exp_f32 v23, v23
    v_exp_f32 v24, v24
    v_exp_f32 v25, v25
    v_exp_f32 v26, v26
    v_exp_f32 v27, v27
    v_cvt_pk_bf16_f32 v88, v16, v17
    v_cvt_pk_bf16_f32 v89, v18, v19
    v_cvt_pk_bf16_f32 v90, v20, v21
    v_cvt_pk_bf16_f32 v91, v22, v23
    v_exp_f32 v28, v28
    v_exp_f32 v29, v29
    v_exp_f32 v30, v30
    v_exp_f32 v31, v31
    s_waitcnt vmcnt(6)
    v_mfma_f32_32x32x16_bf16 v[64:79], v[112:115], v[88:91], v[64:79]
    v_cvt_pk_bf16_f32 v92, v24, v25
    v_cvt_pk_bf16_f32 v93, v26, v27
    v_cvt_pk_bf16_f32 v94, v28, v29
    v_cvt_pk_bf16_f32 v95, v30, v31
    s_nop 1
    v_mfma_f32_32x32x16_bf16 v[64:79], v[116:119], v[92:95], v[64:79]
    s_waitcnt lgkmcnt(0)
    v_mfma_f32_32x32x16_bf16 v[16:31], v[80:83], v[4:7], v[48:63]
    ds_read_b128 v[84:87], v10 offset:5120
    s_mov_b64 exec, s[36:37]
    buffer_load_dwordx4 v[112:115], v3, s[20:23], s43 offen
    buffer_load_dwordx4 v[116:119], v3, s[20:23], s43 offen offset:512
    s_mov_b64 exec, -1
    s_add_u32 s43, s43, 1024
    v_exp_f32 v32, v32
    v_exp_f32 v33, v33
    v_exp_f32 v34, v34
    v_exp_f32 v35, v35
    v_exp_f32 v36, v36
    v_exp_f32 v37, v37
    v_exp_f32 v38, v38
    v_exp_f32 v39, v39
    v_exp_f32 v40, v40
    v_exp_f32 v41, v41
    v_exp_f32 v42, v42
    v_exp_f32 v43, v43
    v_cvt_pk_bf16_f32 v88, v32, v33
    v_cvt_pk_bf16_f32 v89, v34, v35
    v_cvt_pk_bf16_f32 v90, v36, v37
    v_cvt_pk_bf16_f32 v91, v38, v39
    v_exp_f32 v44, v44
    v_exp_f32 v45, v45
    v_exp_f32 v46, v46
    v_exp_f32 v47, v47
    s_waitcnt vmcnt(6)
    v_mfma_f32_32x32x16_bf16 v[64:79], v[120:123], v[88:91], v[64:79]
    v_cvt_pk_bf16_f32 v92, v40, v41
    v_cvt_pk_bf16_f32 v93, v42, v43
    v_cvt_pk_bf16_f32 v94, v44, v45
    v_cvt_pk_bf16_f32 v95, v46, v47
    s_nop 1
    v_mfma_f32_32x32x16_bf16 v[64:79], v[124:127], v[92:95], v[64:79]
    v_add_u32 v10, 4096, v10
    s_add_u32 s38, s38, 4
    s_cmp_lt_u32 s38, 64
    s_cbranch_scc1 P2_l2_kernel_5
    s_nop 15
    v_cmp_gt_f32 vcc, 0x21800000, v72
    s_waitcnt vmcnt(0) lgkmcnt(0)
    s_cmp_eq_u32 s41, 0
    s_cbranch_scc1 EPI_l2_kernel_4
    s_cbranch_vccz EPI_l2_kernel_4
    s_branch FB_l2_kernel_8
BB_l2_kernel_7:
    s_barrier
    s_branch NB_l2_kernel_6
FB_l2_kernel_8:
    s_mov_b32 s41, 0
    s_mov_b32 s43, s44
    s_mov_b64 exec, s[36:37]
    buffer_load_dwordx4 v[96:99], v3, s[20:23], s43 offen
    buffer_load_dwordx4 v[100:103], v3, s[20:23], s43 offen offset:512
    s_mov_b64 exec, -1
    s_add_u32 s43, s43, 1024
    s_mov_b64 exec, s[36:37]
    buffer_load_dwordx4 v[104:107], v3, s[20:23], s43 offen
    buffer_load_dwordx4 v[108:111], v3, s[20:23], s43 offen offset:512
    s_mov_b64 exec, -1
    s_add_u32 s43, s43, 1024
    s_mov_b64 exec, s[36:37]
    buffer_load_dwordx4 v[112:115], v3, s[20:23], s43 offen
    buffer_load_dwordx4 v[116:119], v3, s[20:23], s43 offen offset:512
    s_mov_b64 exec, -1
    s_add_u32 s43, s43, 1024
    v_mov_b32 v15, 0xff800000
    v_mov_b32 v10, v2
    ds_read_b128 v[80:83], v10
    ds_read_b128 v[84:87], v10 offset:1024
    s_waitcnt lgkmcnt(1)
    v_mfma_f32_32x32x16_bf16 v[16:31], v[80:83], v[4:7], 0
    ds_read_b128 v[80:83], v10 offset:2048
    s_mov_b32 s38, 0
P1_l2_kernel_9:
    s_waitcnt lgkmcnt(1)
    v_mfma_f32_32x32x16_bf16 v[32:47], v[84:87], v[4:7], 0
    ds_read_b128 v[84:87], v10 offset:3072
    s_nop 9
    v_max3_f32 v15, v16, v17, v15
    v_max3_f32 v15, v18, v19, v15
    v_max3_f32 v15, v20, v21, v15
    v_max3_f32 v15, v22, v23, v15
    v_max3_f32 v15, v24, v25, v15
    v_max3_f32 v15, v26, v27, v15
    v_max3_f32 v15, v28, v29, v15
    v_max3_f32 v15, v30, v31, v15
    s_waitcnt lgkmcnt(1)
    v_mfma_f32_32x32x16_bf16 v[16:31], v[80:83], v[4:7], 0
    ds_read_b128 v[80:83], v10 offset:4096
    v_add_u32 v10, 2048, v10
    s_nop 8
    v_max3_f32 v15, v32, v33, v15
    v_max3_f32 v15, v34, v35, v15
    v_max3_f32 v15, v36, v37, v15
    v_max3_f32 v15, v38, v39, v15
    v_max3_f32 v15, v40, v41, v15
    v_max3_f32 v15, v42, v43, v15
    v_max3_f32 v15, v44, v45, v15
    v_max3_f32 v15, v46, v47, v15
    s_add_u32 s38, s38, 2
    s_cmp_lt_u32 s38, 64
    s_cbranch_scc1 P1_l2_kernel_9
    v_mov_b32 v14, v15
    s_nop 1
    v_permlane32_swap_b32 v15, v14
    s_nop 1
    v_max_f32 v15, v15, v14
    v_sub_f32 v15, 0, v15
    v_mov_b32 v48, v15
    v_mov_b32 v49, v15
    v_mov_b32 v50, v15
    v_mov_b32 v51, v15
    v_mov_b32 v52, v15
    v_mov_b32 v53, v15
    v_mov_b32 v54, v15
    v_mov_b32 v55, v15
    v_mov_b32 v56, v15
    v_mov_b32 v57, v15
    v_mov_b32 v58, v15
    v_mov_b32 v59, v15
    v_mov_b32 v60, v15
    v_mov_b32 v61, v15
    v_mov_b32 v62, v15
    v_mov_b32 v63, v15
    s_waitcnt lgkmcnt(0)
    s_nop 3
    s_branch P2S_l2_kernel_3
EPI_l2_kernel_4:
    v_rcp_f32 v8, v72
    s_nop 0
    v_mul_f32 v64, v64, v8
    v_mul_f32 v65, v65, v8
    v_mul_f32 v66, v66, v8
    v_mul_f32 v67, v67, v8
    v_mul_f32 v68, v68, v8
    v_mul_f32 v69, v69, v8
    v_mul_f32 v70, v70, v8
    v_mul_f32 v71, v71, v8
    v_cvt_pk_bf16_f32 v88, v64, v65
    v_cvt_pk_bf16_f32 v89, v66, v67
    v_cvt_pk_bf16_f32 v90, v68, v69
    v_cvt_pk_bf16_f32 v91, v70, v71
    s_add_u32 s27, s27, 6291456
    buffer_store_dwordx4 v[88:91], v2, s[20:23], s27 offen
    s_endpgm
CONV_l2_kernel_1:
    s_sub_u32 s2, s2, 256
    s_load_dwordx2 s[68:69], s[0:1], 48
    s_load_dwordx2 s[70:71], s[0:1], 80
    s_load_dwordx2 s[56:57], s[0:1], 96
    v_mov_b32 v1, v0
    v_lshrrev_b32 v2, 6, v0
    v_and_b32 v0, 63, v0
    s_nop 0
    v_readfirstlane_b32 s3, v2
    s_lshr_b32 s4, s3, 2
    s_and_b32 s5, s3, 3
    s_and_b32 s24, s2, 7
    s_lshl_b32 s24, s24, 5
    s_lshr_b32 s25, s2, 3
    s_add_u32 s24, s24, s25
    s_lshl_b32 s24, s24, 1
    s_lshl_b32 s25, s24, 1
    s_waitcnt lgkmcnt(0)
    s_mov_b32 s48, s70
    s_and_b32 s49, s71, 0xffff
    s_mov_b32 s50, 4194304
    s_mov_b32 s51, 0x00020000
    s_mov_b32 s12, s56
    s_and_b32 s13, s57, 0xffff
    s_mov_b32 s14, 13631488
    s_mov_b32 s15, 0x00020000
    s_add_u32 s68, s68, s25
    s_addc_u32 s69, s69, 0
    s_load_dword s54, s[68:69], 0
    s_add_u32 s26, s24, s4
    s_lshl_b32 s26, s26, 12
    s_add_u32 s27, s26, 11534336
    s_add_u32 s16, s56, s27
    s_addc_u32 s17, s57, 0
    s_and_b32 s17, s17, 0xffff
    s_mov_b32 s18, 4096
    s_mov_b32 s19, 0x00020000
    v_and_b32 v56, 255, v1
    v_lshlrev_b32 v57, 4, v56
    v_subrev_u32 v3, 32, v57
    v_add_u32 v4, 4096, v3
    buffer_load_dwordx4 v[64:67], v3, s[16:19], 0 offen
    buffer_load_dwordx4 v[68:71], v3, s[16:19], 0 offen offset:16
    s_add_u32 s27, s26, 9437184
    buffer_load_dwordx4 v[80:83], v57, s[12:15], s27 offen
    buffer_load_dwordx4 v[72:75], v4, s[16:19], 0 offen
    buffer_load_dwordx4 v[76:79], v4, s[16:19], 0 offen offset:16
    s_mul_i32 s28, s4, 4640
    s_mul_i32 s29, s4, 34304
    v_add_u32 v58, s28, v57
    v_add_u32 v59, s29, v57
    v_add_u32 v60, 4096, v59
    v_mov_b32 v16, 0
    v_mov_b32 v17, 0
    v_mov_b32 v18, 0
    v_mov_b32 v19, 0
    v_cmp_gt_u32 vcc, 32, v56
    s_and_saveexec_b64 s[30:31], vcc
    ds_write_b128 v58, v[16:19] offset:1024
    s_mov_b64 exec, s[30:31]
    v_cmp_gt_u32 vcc, 2, v56
    s_and_saveexec_b64 s[30:31], vcc
    ds_write_b128 v58, v[16:19] offset:5632
    s_mov_b64 exec, s[30:31]
    v_and_b32 v14, 15, v0
    v_lshrrev_b32 v11, 4, v0
    v_lshlrev_b32 v12, 3, v11
    v_sub_u32 v12, v12, v14
    v_add_u32 v12, 2063, v12
    v_and_b32 v13, 7, v12
    v_sub_u32 v12, v12, v13
    s_movk_i32 s38, 4288
    v_mul_lo_u32 v13, v13, s38
    v_lshlrev_b32 v12, 1, v12
    v_add_u32 v12, v12, v13
    v_add_u32 v61, 9344, v12
    v_add_u32 v61, s29, v61
    v_lshlrev_b32 v12, 5, v14
    v_lshlrev_b32 v13, 4, v11
    v_add_u32 v12, v12, v13
    v_add_u32 v62, 576, v12
    v_add_u32 v62, s28, v62
    s_waitcnt vmcnt(3)
    v_mov_b32 v26, v65
    v_mov_b32 v27, v66
    v_mov_b32 v28, v67
    v_mov_b32 v29, v68
    v_mov_b32 v30, v69
    v_mov_b32 v31, v70
    v_alignbit_b32 v32, v65, v64, 16
    v_alignbit_b32 v33, v66, v65, 16
    v_alignbit_b32 v34, v67, v66, 16
    v_alignbit_b32 v35, v68, v67, 16
    v_alignbit_b32 v36, v69, v68, 16
    v_alignbit_b32 v37, v70, v69, 16
    v_alignbit_b32 v38, v71, v70, 16
    v_mov_b32 v42, v33
    v_mov_b32 v43, v34
    v_mov_b32 v44, v35
    v_mov_b32 v45, v36
    v_mov_b32 v46, v37
    v_mov_b32 v47, v38
    ds_write_b128 v59, v[64:67] offset:10304
    ds_write_b128 v59, v[32:35] offset:14592
    ds_write_b128 v59, v[26:29] offset:18880
    ds_write_b128 v59, v[42:45] offset:23168
    ds_write_b128 v59, v[66:69] offset:27456
    ds_write_b128 v59, v[34:37] offset:31744
    ds_write_b128 v59, v[28:31] offset:36032
    ds_write_b128 v59, v[44:47] offset:40320
    s_waitcnt vmcnt(2)
    ds_write_b128 v58, v[80:83] offset:1536
    s_waitcnt vmcnt(0)
    v_cmp_gt_u32 vcc, 6, v56
    s_and_saveexec_b64 s[30:31], vcc
    v_mov_b32 v26, v73
    v_mov_b32 v27, v74
    v_mov_b32 v28, v75
    v_mov_b32 v29, v76
    v_mov_b32 v30, v77
    v_mov_b32 v31, v78
    v_alignbit_b32 v32, v73, v72, 16
    v_alignbit_b32 v33, v74, v73, 16
    v_alignbit_b32 v34, v75, v74, 16
    v_alignbit_b32 v35, v76, v75, 16
    v_alignbit_b32 v36, v77, v76, 16
    v_alignbit_b32 v37, v78, v77, 16
    v_alignbit_b32 v38, v79, v78, 16
    v_mov_b32 v42, v33
    v_mov_b32 v43, v34
    v_mov_b32 v44, v35
    v_mov_b32 v45, v36
    v_mov_b32 v46, v37
    v_mov_b32 v47, v38
    ds_write_b128 v60, v[72:75] offset:10304
    ds_write_b128 v60, v[32:35] offset:14592
    ds_write_b128 v60, v[26:29] offset:18880
    ds_write_b128 v60, v[42:45] offset:23168
    ds_write_b128 v60, v[74:77] offset:27456
    ds_write_b128 v60, v[34:37] offset:31744
    ds_write_b128 v60, v[28:31] offset:36032
    ds_write_b128 v60, v[44:47] offset:40320
    s_mov_b64 exec, s[30:31]
    s_waitcnt lgkmcnt(0)
    s_barrier
    s_sub_u32 s39, 7, s5
    v_mov_b32 v48, 0
    v_mov_b32 v49, 0
    v_mov_b32 v50, 0
    v_mov_b32 v51, 0
    v_mov_b32 v8, v61
    s_lshl_b32 s40, s39, 9
    v_add_u32 v9, s40, v62
    ds_read_b128 v[96:99], v8 offset:960
    ds_read_b128 v[112:115], v9 offset:960
    ds_read_b128 v[100:103], v8 offset:896
    ds_read_b128 v[116:119], v9 offset:896
    ds_read_b128 v[104:107], v8 offset:832
    ds_read_b128 v[120:123], v9 offset:832
    ds_read_b128 v[108:111], v8 offset:768
    ds_read_b128 v[124:127], v9 offset:768
    s_mov_b32 s41, 0
CV_l2_kernel_10:
    s_waitcnt lgkmcnt(6)
    v_mfma_f32_16x16x32_bf16 v[48:51], v[96:99], v[112:115], v[48:51]
    ds_read_b128 v[96:99], v8 offset:704
    ds_read_b128 v[112:115], v9 offset:704
    s_waitcnt lgkmcnt(6)
    v_mfma_f32_16x16x32_bf16 v[48:51], v[100:103], v[116:119], v[48:51]
    ds_read_b128 v[100:103], v8 offset:640
    ds_read_b128 v[116:119], v9 offset:640
    s_waitcnt lgkmcnt(6)
    v_mfma_f32_16x16x32_bf16 v[48:51], v[104:107], v[120:123], v[48:51]
    ds_read_b128 v[104:107], v8 offset:576
    ds_read_b128 v[120:123], v9 offset:576
    s_waitcnt lgkmcnt(6)
    v_mfma_f32_16x16x32_bf16 v[48:51], v[108:111], v[124:127], v[48:51]
    ds_read_b128 v[108:111], v8 offset:512
    ds_read_b128 v[124:127], v9 offset:512
    s_waitcnt lgkmcnt(6)
    v_mfma_f32_16x16x32_bf16 v[48:51], v[96:99], v[112:115], v[48:51]
    ds_read_b128 v[96:99], v8 offset:448
    ds_read_b128 v[112:115], v9 offset:448
    s_waitcnt lgkmcnt(6)
    v_mfma_f32_16x16x32_bf16 v[48:51], v[100:103], v[116:119], v[48:51]
    ds_read_b128 v[100:103], v8 offset:384
    ds_read_b128 v[116:119], v9 offset:384
    s_waitcnt lgkmcnt(6)
    v_mfma_f32_16x16x32_bf16 v[48:51], v[104:107], v[120:123], v[48:51]
    ds_read_b128 v[104:107], v8 offset:320
    ds_read_b128 v[120:123], v9 offset:320
    s_waitcnt lgkmcnt(6)
    v_mfma_f32_16x16x32_bf16 v[48:51], v[108:111], v[124:127], v[48:51]
    ds_read_b128 v[108:111], v8 offset:256
    ds_read_b128 v[124:127], v9 offset:256
    v_subrev_u32 v8, 512, v8
    v_subrev_u32 v9, 512, v9
    s_add_u32 s41, s41, 1
    s_cmp_le_u32 s41, s39
    s_cbranch_scc1 CV_l2_kernel_10
    s_waitcnt lgkmcnt(6)
    v_mfma_f32_16x16x32_bf16 v[48:51], v[96:99], v[112:115], v[48:51]
    s_waitcnt lgkmcnt(0)
    s_mov_b32 s39, s5
    v_mov_b32 v52, 0
    v_mov_b32 v53, 0
    v_mov_b32 v54, 0
    v_mov_b32 v55, 0
    v_mov_b32 v8, v61
    s_lshl_b32 s40, s39, 9
    v_add_u32 v9, s40, v62
    ds_read_b128 v[96:99], v8 offset:960
    ds_read_b128 v[112:115], v9 offset:960
    ds_read_b128 v[100:103], v8 offset:896
    ds_read_b128 v[116:119], v9 offset:896
    ds_read_b128 v[104:107], v8 offset:832
    ds_read_b128 v[120:123], v9 offset:832
    ds_read_b128 v[108:111], v8 offset:768
    ds_read_b128 v[124:127], v9 offset:768
    s_mov_b32 s41, 0
CV_l2_kernel_11:
    s_waitcnt lgkmcnt(6)
    v_mfma_f32_16x16x32_bf16 v[52:55], v[96:99], v[112:115], v[52:55]
    ds_read_b128 v[96:99], v8 offset:704
    ds_read_b128 v[112:115], v9 offset:704
    s_waitcnt lgkmcnt(6)
    v_mfma_f32_16x16x32_bf16 v[52:55], v[100:103], v[116:119], v[52:55]
    ds_read_b128 v[100:103], v8 offset:640
    ds_read_b128 v[116:119], v9 offset:640
    s_waitcnt lgkmcnt(6)
    v_mfma_f32_16x16x32_bf16 v[52:55], v[104:107], v[120:123], v[52:55]
    ds_read_b128 v[104:107], v8 offset:576
    ds_read_b128 v[120:123], v9 offset:576
    s_waitcnt lgkmcnt(6)
    v_mfma_f32_16x16x32_bf16 v[52:55], v[108:111], v[124:127], v[52:55]
    ds_read_b128 v[108:111], v8 offset:512
    ds_read_b128 v[124:127], v9 offset:512
    s_waitcnt lgkmcnt(6)
    v_mfma_f32_16x16x32_bf16 v[52:55], v[96:99], v[112:115], v[52:55]
    ds_read_b128 v[96:99], v8 offset:448
    ds_read_b128 v[112:115], v9 offset:448
    s_waitcnt lgkmcnt(6)
    v_mfma_f32_16x16x32_bf16 v[52:55], v[100:103], v[116:119], v[52:55]
    ds_read_b128 v[100:103], v8 offset:384
    ds_read_b128 v[116:119], v9 offset:384
    s_waitcnt lgkmcnt(6)
    v_mfma_f32_16x16x32_bf16 v[52:55], v[104:107], v[120:123], v[52:55]
    ds_read_b128 v[104:107], v8 offset:320
    ds_read_b128 v[120:123], v9 offset:320
    s_waitcnt lgkmcnt(6)
    v_mfma_f32_16x16x32_bf16 v[52:55], v[108:111], v[124:127], v[52:55]
    ds_read_b128 v[108:111], v8 offset:256
    ds_read_b128 v[124:127], v9 offset:256
    v_subrev_u32 v8, 512, v8
    v_subrev_u32 v9, 512, v9
    s_add_u32 s41, s41, 1
    s_cmp_le_u32 s41, s39
    s_cbranch_scc1 CV_l2_kernel_11
    s_waitcnt lgkmcnt(6)
    v_mfma_f32_16x16x32_bf16 v[52:55], v[96:99], v[112:115], v[52:55]
    s_waitcnt lgkmcnt(0)
    s_lshl_b32 s42, s54, 16
    s_and_b32 s43, s54, 0xffff0000
    s_cmp_eq_u32 s4, 0
    s_cselect_b32 s42, s42, s43
    s_lshl_b32 s44, s4, 1
    s_sub_u32 s39, 7, s5
    v_lshlrev_b32 v12, 4, v14
    v_lshlrev_b32 v13, 2, v11
    v_add_u32 v12, v12, v13
    s_lshl_b32 s40, s39, 8
    v_add_u32 v12, s40, v12
    v_lshlrev_b32 v13, 1, v12
    v_add_u32 v13, s28, v13
    ds_read_b64 v[16:17], v13 offset:1536
    v_lshlrev_b32 v36, 2, v12
    v_add_u32 v36, s44, v36
    s_nop 3
    s_waitcnt lgkmcnt(0)
    v_lshlrev_b32 v20, 16, v16
    v_and_b32 v21, 0xffff0000, v16
    v_mul_f32 v20, s42, v20
    v_mul_f32 v21, s42, v21
    v_cvt_pk_bf16_f32 v22, v20, v21
    v_cvt_pk_bf16_f32 v23, v48, v49
    v_lshlrev_b32 v24, 16, v22
    v_and_b32 v25, 0xffff0000, v22
    v_lshlrev_b32 v26, 16, v23
    v_and_b32 v27, 0xffff0000, v23
    v_add_f32 v24, v24, v26
    v_add_f32 v25, v25, v27
    v_cvt_pk_bf16_f32 v32, v24, v25
    v_lshlrev_b32 v20, 16, v17
    v_and_b32 v21, 0xffff0000, v17
    v_mul_f32 v20, s42, v20
    v_mul_f32 v21, s42, v21
    v_cvt_pk_bf16_f32 v22, v20, v21
    v_cvt_pk_bf16_f32 v23, v50, v51
    v_lshlrev_b32 v24, 16, v22
    v_and_b32 v25, 0xffff0000, v22
    v_lshlrev_b32 v26, 16, v23
    v_and_b32 v27, 0xffff0000, v23
    v_add_f32 v24, v24, v26
    v_add_f32 v25, v25, v27
    v_cvt_pk_bf16_f32 v33, v24, v25
    s_mov_b32 s39, s5
    v_lshlrev_b32 v12, 4, v14
    v_lshlrev_b32 v13, 2, v11
    v_add_u32 v12, v12, v13
    s_lshl_b32 s40, s39, 8
    v_add_u32 v12, s40, v12
    v_lshlrev_b32 v13, 1, v12
    v_add_u32 v13, s28, v13
    ds_read_b64 v[16:17], v13 offset:1536
    v_lshlrev_b32 v37, 2, v12
    v_add_u32 v37, s44, v37
    s_nop 3
    s_waitcnt lgkmcnt(0)
    v_lshlrev_b32 v20, 16, v16
    v_and_b32 v21, 0xffff0000, v16
    v_mul_f32 v20, s42, v20
    v_mul_f32 v21, s42, v21
    v_cvt_pk_bf16_f32 v22, v20, v21
    v_cvt_pk_bf16_f32 v23, v52, v53
    v_lshlrev_b32 v24, 16, v22
    v_and_b32 v25, 0xffff0000, v22
    v_lshlrev_b32 v26, 16, v23
    v_and_b32 v27, 0xffff0000, v23
    v_add_f32 v24, v24, v26
    v_add_f32 v25, v25, v27
    v_cvt_pk_bf16_f32 v34, v24, v25
    v_lshlrev_b32 v20, 16, v17
    v_and_b32 v21, 0xffff0000, v17
    v_mul_f32 v20, s42, v20
    v_mul_f32 v21, s42, v21
    v_cvt_pk_bf16_f32 v22, v20, v21
    v_cvt_pk_bf16_f32 v23, v54, v55
    v_lshlrev_b32 v24, 16, v22
    v_and_b32 v25, 0xffff0000, v22
    v_lshlrev_b32 v26, 16, v23
    v_and_b32 v27, 0xffff0000, v23
    v_add_f32 v24, v24, v26
    v_add_f32 v25, v25, v27
    v_cvt_pk_bf16_f32 v35, v24, v25
    s_barrier
    ds_write_b16 v36, v32 offset:10304
    ds_write_b16_d16_hi v36, v32 offset:10308
    ds_write_b16 v36, v33 offset:10312
    ds_write_b16_d16_hi v36, v33 offset:10316
    ds_write_b16 v37, v34 offset:10304
    ds_write_b16_d16_hi v37, v34 offset:10308
    ds_write_b16 v37, v35 offset:10312
    ds_write_b16_d16_hi v37, v35 offset:10316
    s_waitcnt lgkmcnt(0)
    s_barrier
    v_lshlrev_b32 v12, 4, v1
    ds_read_b128 v[16:19], v12 offset:10304
    v_lshlrev_b32 v13, 13, v1
    v_add_u32 v13, s25, v13
    s_movk_i32 s44, 4096
    s_waitcnt lgkmcnt(0)
    buffer_store_dword v16, v13, s[48:51], 0 offen offset:0
    buffer_store_dword v17, v13, s[48:51], 0 offen offset:2048
    buffer_store_dword v18, v13, s[48:51], s44 offen offset:0
    buffer_store_dword v19, v13, s[48:51], s44 offen offset:2048
l2_kernel_end:
    s_endpgm
.globl gemm2_kernel
.p2align 8
.type gemm2_kernel,@function
gemm2_kernel:
    s_cmp_ge_u32 s2, 256
    s_cbranch_scc1 gemm2_kernel_end
    s_load_dwordx2 s[6:7], s[0:1], 72
    s_load_dwordx2 s[8:9], s[0:1], 96
    s_load_dwordx2 s[10:11], s[0:1], 80
    v_lshrrev_b32 v1, 6, v0
    v_and_b32 v0, 63, v0
    s_nop 0
    v_readfirstlane_b32 s3, v1
    s_and_b32 s26, s2, 7
    s_lshr_b32 s27, s2, 3
    s_lshr_b32 s24, s26, 1
    s_lshl_b32 s24, s24, 3
    s_and_b32 s28, s27, 7
    s_add_u32 s24, s24, s28
    s_and_b32 s25, s26, 1
    s_lshl_b32 s25, s25, 2
    s_lshr_b32 s28, s27, 3
    s_add_u32 s25, s25, s28
    s_and_b32 s26, s3, 1
    s_lshr_b32 s27, s3, 1
    s_waitcnt lgkmcnt(0)
    s_mov_b32 s12, s10
    s_and_b32 s13, s11, 0xffff
    s_mov_b32 s14, 4194304
    s_mov_b32 s15, 0x00020000
    s_mov_b32 s16, s6
    s_and_b32 s17, s7, 0xffff
    s_mov_b32 s18, 524288
    s_mov_b32 s19, 0x00020000
    s_mov_b32 s20, s8
    s_and_b32 s21, s9, 0xffff
    s_mov_b32 s22, 13631488
    s_mov_b32 s23, 0x00020000
    v_lshrrev_b32 v3, 3, v0
    v_and_b32 v4, 2, v3
    v_lshlrev_b32 v4, 1, v4
    v_and_b32 v5, 7, v0
    v_xor_b32 v5, v5, v4
    v_lshlrev_b32 v5, 4, v5
    v_and_b32 v6, 3, v3
    v_and_b32 v7, 4, v3
    v_lshlrev_b32 v7, 1, v7
    v_add_u32 v6, v6, v7
    v_lshlrev_b32 v6, 10, v6
    v_add_u32 v4, v6, v5
    s_lshl_b32 s28, s25, 7
    v_lshlrev_b32 v2, 4, v0
    s_lshl_b32 s29, s24, 1
    s_add_u32 s29, s29, s26
    s_lshl_b32 s29, s29, 10
    s_add_u32 s29, s29, 6291456
    s_lshl_b32 s30, s3, 4
    s_add_u32 s34, s30, 16
DMA_gemm2_kernel_1:
    s_lshl_b32 s31, s30, 10
    s_mov_b32 m0, s31
    s_lshr_b32 s32, s30, 1
    s_lshl_b32 s32, s32, 14
    s_and_b32 s33, s30, 1
    s_lshl_b32 s33, s33, 12
    s_add_u32 s32, s32, s33
    s_add_u32 s32, s32, s28
    buffer_load_dwordx4 v4, s[16:19], s32 offen lds
    s_add_u32 s30, s30, 1
    s_cmp_lt_u32 s30, s34
    s_cbranch_scc1 DMA_gemm2_kernel_1
    buffer_load_dwordx4 v[128:131], v2, s[20:23], s29 offen
    s_add_u32 s29, s29, 65536
    buffer_load_dwordx4 v[132:135], v2, s[20:23], s29 offen
    s_add_u32 s29, s29, 65536
    buffer_load_dwordx4 v[136:139], v2, s[20:23], s29 offen
    s_add_u32 s29, s29, 65536
    buffer_load_dwordx4 v[140:143], v2, s[20:23], s29 offen
    s_add_u32 s29, s29, 65536
    buffer_load_dwordx4 v[144:147], v2, s[20:23], s29 offen
    s_add_u32 s29, s29, 65536
    buffer_load_dwordx4 v[148:151], v2, s[20:23], s29 offen
    s_add_u32 s29, s29, 65536
    buffer_load_dwordx4 v[152:155], v2, s[20:23], s29 offen
    s_add_u32 s29, s29, 65536
    buffer_load_dwordx4 v[156:159], v2, s[20:23], s29 offen
    s_add_u32 s29, s29, 65536
    v_lshrrev_b32 v7, 5, v0
    v_lshlrev_b32 v7, 3, v7
    v_and_b32 v8, 15, v0
    v_lshrrev_b32 v8, 2, v8
    v_add_u32 v7, v7, v8
    v_lshlrev_b32 v7, 7, v7
    v_lshrrev_b32 v8, 1, v8
    v_xor_b32 v8, s27, v8
    v_lshlrev_b32 v8, 6, v8
    v_add_u32 v7, v7, v8
    v_and_b32 v8, 1, v0
    v_lshlrev_b32 v8, 5, v8
    v_add_u32 v7, v7, v8
    v_lshrrev_b32 v8, 4, v0
    v_and_b32 v8, 1, v8
    v_lshlrev_b32 v8, 4, v8
    v_add_u32 v7, v7, v8
    v_lshrrev_b32 v8, 1, v0
    v_and_b32 v8, 1, v8
    v_lshlrev_b32 v8, 3, v8
    v_add_u32 v7, v7, v8
    v_mov_b32 v16, 0
    v_mov_b32 v17, 0
    v_mov_b32 v18, 0
    v_mov_b32 v19, 0
    v_mov_b32 v20, 0
    v_mov_b32 v21, 0
    v_mov_b32 v22, 0
    v_mov_b32 v23, 0
    v_mov_b32 v24, 0
    v_mov_b32 v25, 0
    v_mov_b32 v26, 0
    v_mov_b32 v27, 0
    v_mov_b32 v28, 0
    v_mov_b32 v29, 0
    v_mov_b32 v30, 0
    v_mov_b32 v31, 0
    s_waitcnt vmcnt(8)
    s_barrier
    ds_read_b64_tr_b16 v[32:33], v7 offset:0
    ds_read_b64_tr_b16 v[34:35], v7 offset:512
    ds_read_b64_tr_b16 v[36:37], v7 offset:2048
    ds_read_b64_tr_b16 v[38:39], v7 offset:2560
    ds_read_b64_tr_b16 v[40:41], v7 offset:4096
    ds_read_b64_tr_b16 v[42:43], v7 offset:4608
    s_mov_b32 s30, 0
MM_gemm2_kernel_2:
    ds_read_b64_tr_b16 v[44:45], v7 offset:6144
    ds_read_b64_tr_b16 v[46:47], v7 offset:6656
    s_waitcnt lgkmcnt(6)
    s_waitcnt vmcnt(7)
    v_mfma_f32_32x32x16_bf16 v[16:31], v[32:35], v[128:131], v[16:31]
    buffer_load_dwordx4 v[128:131], v2, s[20:23], s29 offen
    s_add_u32 s29, s29, 65536
    ds_read_b64_tr_b16 v[32:33], v7 offset:8192
    ds_read_b64_tr_b16 v[34:35], v7 offset:8704
    s_waitcnt lgkmcnt(6)
    s_waitcnt vmcnt(7)
    v_mfma_f32_32x32x16_bf16 v[16:31], v[36:39], v[132:135], v[16:31]
    buffer_load_dwordx4 v[132:135], v2, s[20:23], s29 offen
    s_add_u32 s29, s29, 65536
    ds_read_b64_tr_b16 v[36:37], v7 offset:10240
    ds_read_b64_tr_b16 v[38:39], v7 offset:10752
    s_waitcnt lgkmcnt(6)
    s_waitcnt vmcnt(7)
    v_mfma_f32_32x32x16_bf16 v[16:31], v[40:43], v[136:139], v[16:31]
    buffer_load_dwordx4 v[136:139], v2, s[20:23], s29 offen
    s_add_u32 s29, s29, 65536
    ds_read_b64_tr_b16 v[40:41], v7 offset:12288
    ds_read_b64_tr_b16 v[42:43], v7 offset:12800
    s_waitcnt lgkmcnt(6)
    s_waitcnt vmcnt(7)
    v_mfma_f32_32x32x16_bf16 v[16:31], v[44:47], v[140:143], v[16:31]
    buffer_load_dwordx4 v[140:143], v2, s[20:23], s29 offen
    s_add_u32 s29, s29, 65536
    ds_read_b64_tr_b16 v[44:45], v7 offset:14336
    ds_read_b64_tr_b16 v[46:47], v7 offset:14848
    s_waitcnt lgkmcnt(6)
    s_waitcnt vmcnt(7)
    v_mfma_f32_32x32x16_bf16 v[16:31], v[32:35], v[144:147], v[16:31]
    buffer_load_dwordx4 v[144:147], v2, s[20:23], s29 offen
    s_add_u32 s29, s29, 65536
    ds_read_b64_tr_b16 v[32:33], v7 offset:16384
    ds_read_b64_tr_b16 v[34:35], v7 offset:16896
    s_waitcnt lgkmcnt(6)
    s_waitcnt vmcnt(7)
    v_mfma_f32_32x32x16_bf16 v[16:31], v[36:39], v[148:151], v[16:31]
    buffer_load_dwordx4 v[148:151], v2, s[20:23], s29 offen
    s_add_u32 s29, s29, 65536
    ds_read_b64_tr_b16 v[36:37], v7 offset:18432
    ds_read_b64_tr_b16 v[38:39], v7 offset:18944
    s_waitcnt lgkmcnt(6)
    s_waitcnt vmcnt(7)
    v_mfma_f32_32x32x16_bf16 v[16:31], v[40:43], v[152:155], v[16:31]
    buffer_load_dwordx4 v[152:155], v2, s[20:23], s29 offen
    s_add_u32 s29, s29, 65536
    ds_read_b64_tr_b16 v[40:41], v7 offset:20480
    ds_read_b64_tr_b16 v[42:43], v7 offset:20992
    s_waitcnt lgkmcnt(6)
    s_waitcnt vmcnt(7)
    v_mfma_f32_32x32x16_bf16 v[16:31], v[44:47], v[156:159], v[16:31]
    buffer_load_dwordx4 v[156:159], v2, s[20:23], s29 offen
    s_add_u32 s29, s29, 65536
    v_add_u32 v7, 16384, v7
    s_add_u32 s30, s30, 1
    s_cmp_lt_u32 s30, 4
    s_cbranch_scc1 MM_gemm2_kernel_2
    s_waitcnt vmcnt(0) lgkmcnt(0)
    s_nop 15
    v_cvt_pk_bf16_f32 v48, v16, v17
    v_cvt_pk_bf16_f32 v49, v18, v19
    v_cvt_pk_bf16_f32 v50, v20, v21
    v_cvt_pk_bf16_f32 v51, v22, v23
    v_cvt_pk_bf16_f32 v52, v24, v25
    v_cvt_pk_bf16_f32 v53, v26, v27
    v_cvt_pk_bf16_f32 v54, v28, v29
    v_cvt_pk_bf16_f32 v55, v30, v31
    s_lshl_b32 s30, s24, 6
    s_lshl_b32 s31, s26, 5
    s_add_u32 s30, s30, s31
    v_and_b32 v3, 31, v0
    v_add_u32 v3, s30, v3
    v_lshlrev_b32 v3, 11, v3
    v_lshrrev_b32 v5, 5, v0
    v_lshlrev_b32 v5, 5, v5
    v_add_u32 v3, v3, v5
    s_lshl_b32 s31, s27, 6
    s_add_u32 s31, s31, s28
    s_add_u32 s31, s31, 1024
    buffer_store_dwordx4 v[48:51], v3, s[12:15], s31 offen
    buffer_store_dwordx4 v[52:55], v3, s[12:15], s31 offen offset:16
gemm2_kernel_end:
    s_endpgm
.section .rodata,"a"
.p2align 6
.amdhsa_kernel l1_kernel
  .amdhsa_next_free_vgpr 224
  .amdhsa_next_free_sgpr 96
  .amdhsa_accum_offset 224
  .amdhsa_group_segment_fixed_size 0
  .amdhsa_kernarg_size 104
  .amdhsa_user_sgpr_count 2
  .amdhsa_user_sgpr_kernarg_segment_ptr 1
  .amdhsa_system_sgpr_workgroup_id_x 1
.end_amdhsa_kernel
.p2align 6
.amdhsa_kernel l2_kernel
  .amdhsa_next_free_vgpr 128
  .amdhsa_next_free_sgpr 96
  .amdhsa_accum_offset 128
  .amdhsa_group_segment_fixed_size 0
  .amdhsa_kernarg_size 104
  .amdhsa_user_sgpr_count 2
  .amdhsa_user_sgpr_kernarg_segment_ptr 1
  .amdhsa_system_sgpr_workgroup_id_x 1
.end_amdhsa_kernel
.p2align 6
.amdhsa_kernel gemm2_kernel
  .amdhsa_next_free_vgpr 160
  .amdhsa_next_free_sgpr 96
  .amdhsa_accum_offset 160
  .amdhsa_group_segment_fixed_size 0
  .amdhsa_kernarg_size 104
  .amdhsa_user_sgpr_count 2
  .amdhsa_user_sgpr_kernarg_segment_ptr 1
  .amdhsa_system_sgpr_workgroup_id_x 1
.end_amdhsa_kernel
```
